```python
import torch

def _softmax(x, axis=-1):
    return torch.softmax(x, dim=axis)
def _gelu(x):
    return torch.nn.functional.gelu(x, approximate="tanh")
def _silu(x):
    return torch.nn.functional.silu(x)
def _sigmoid(x):
    return torch.sigmoid(x)
def _layernorm(x, axis=-1, eps=1e-5):
    m = x.mean(dim=axis, keepdim=True)
    v = x.var(dim=axis, keepdim=True, unbiased=False)
    return (x - m) / torch.sqrt(v + eps)
def _scatter_add(tgt, idx, src, axis=0):
    return tgt.clone().index_add_(axis, idx, src)
def _segment_sum(src, seg, n):
    out = torch.zeros((n,) + src.shape[1:], dtype=src.dtype)
    return out.index_add_(0, seg, src)
def _pad(x, pw):
    flat = tuple(v for pair in reversed(pw) for v in pair)
    return torch.nn.functional.pad(x, flat)

kernel_name = 'parallel_sum__mha_block_cached__glu_gated_bilinear__decode'

def setup_inputs():

    _w = (lambda a: (lambda t: t.to(torch.bfloat16) if t.is_floating_point() else t)(torch.as_tensor(a)))
    def _A_setup():
        B, Sq, D = 1, 1, 576
        H, Sk, Dh = 32, 16384, 128
        return {
            "x": _w((lambda *s: torch.randn(*s, dtype=torch.bfloat16) * 0.05)(B, Sq, D)),
            "k_cache": _w((lambda *s: torch.randn(*s, dtype=torch.bfloat16) * 3.2)(B, H, Sk, Dh)),
            "v_cache": _w((lambda *s: torch.randn(*s, dtype=torch.bfloat16) * 1.6)(B, H, Sk, Dh)),
            "wq": _w((lambda *s: torch.randn(*s, dtype=torch.bfloat16) * 3.2)(D, H * Dh) * (D ** -0.5)),
            "wo": _w((lambda *s: torch.randn(*s, dtype=torch.bfloat16) * 1.6)(H * Dh, D) * ((H * Dh) ** -0.5)),
        }
    _A_in = _A_setup()

    def _B_setup():
        B, S, D, F = 1, 1, 576, 4608
        return {
            "x": _w((lambda *s: torch.randn(*s, dtype=torch.bfloat16) * 0.05)(B, S, D)),
            "w_gate": _w((lambda *s: torch.randn(*s, dtype=torch.bfloat16) * 1.6)(D, F) * (D ** -0.5)),
            "w_up": _w((lambda *s: torch.randn(*s, dtype=torch.bfloat16) * 1.6)(D, F) * (D ** -0.5)),
            "w_down": _w((lambda *s: torch.randn(*s, dtype=torch.bfloat16) * 1.6)(F, D) * (F ** -0.5)),
        }
    _B_in = _B_setup()

    return {
        "A_x": _A_in["x"],
        "A_k_cache": _A_in["k_cache"],
        "A_v_cache": _A_in["v_cache"],
        "A_wq": _A_in["wq"],
        "A_wo": _A_in["wo"],
        "B_x": _B_in["x"],
        "B_w_gate": _B_in["w_gate"],
        "B_w_up": _B_in["w_up"],
        "B_w_down": _B_in["w_down"],
    }

def reference(A_x, A_k_cache, A_v_cache, A_wq, A_wo, B_x, B_w_gate, B_w_up, B_w_down):
    def _A_ref(x, k_cache, v_cache, wq, wo):
        B, Sq, D = x.shape
        H, Dh = 32, 128
        q = (lambda x, *d: x.permute(*d))((x @ wq).reshape(B, Sq, H, Dh), 0, 2, 1, 3)
        scores = torch.einsum("bhqd,bhkd->bhqk", q, k_cache) * (Dh ** -0.5)
        p = _softmax(scores, axis=-1)
        o = torch.einsum("bhqk,bhkd->bhqd", p, v_cache)
        return (lambda x, *d: x.permute(*d))(o, 0, 2, 1, 3).reshape(B, Sq, H * Dh) @ wo

    def _B_ref(x, w_gate, w_up, w_down):
        g = torch.einsum("bsd,df->bsf", x, w_gate)
        u = torch.einsum("bsd,df->bsf", x, w_up)
        h = g * u
        return torch.einsum("bsf,fd->bsd", h, w_down)

    x = A_x
    xn = _layernorm(x, axis=-1)
    return x + _A_ref(xn, A_k_cache, A_v_cache, A_wq, A_wo) + _B_ref(xn, B_w_gate, B_w_up, B_w_down)
```

```asm
; @launch grid=(256,1,1) block=(512,1,1) lds=8192
.amdgcn_target "amdgcn-amd-amdhsa--gfx950"
.text
.globl parallel_sum__mha_block_cached__glu_gated_bilinear__decode_kernel
.p2align 8
.type parallel_sum__mha_block_cached__glu_gated_bilinear__decode_kernel,@function
parallel_sum__mha_block_cached__glu_gated_bilinear__decode_kernel:
s_cmp_ge_u32 s2, 256
s_cbranch_scc1 L_end
s_load_dwordx16 s[4:19], s[0:1], 0
s_load_dwordx8 s[20:27], s[0:1], 64
v_lshrrev_b32 v1, 6, v0
v_and_b32 v0, 63, v0
s_and_b32 s33, s2, 7
s_lshr_b32 s34, s2, 3
v_readfirstlane_b32 s28, v1
s_lshl_b32 s31, s33, 5
s_add_u32 s31, s31, s34
s_lshr_b32 s29, s31, 3
s_and_b32 s30, s31, 7
v_lshrrev_b32 v11, 4, v0
v_and_b32 v10, 15, v0
s_mov_b32 s94, 0x40000
s_cmp_lt_u32 s28, 4
s_cbranch_scc0 L_hstart
v_bfe_u32 v1, v0, 2, 2
v_lshlrev_b32 v1, 8, v1
v_lshl_add_u32 v1, v11, 6, v1
v_and_b32 v3, 3, v0
v_lshl_add_u32 v1, v3, 4, v1
s_lshl_b32 s40, s29, 22
s_mul_i32 s50, s29, 917504
s_lshl_b32 s41, s30, 14
s_add_u32 s50, s50, s41
s_lshl_b32 s41, s28, 12
s_add_u32 s50, s50, s41
s_and_b32 s50, s50, 0x3fffff
s_mov_b32 s38, 0x400000
s_mov_b32 s39, 0x20000
s_mov_b32 s46, 0x400000
s_mov_b32 s47, 0x20000
s_waitcnt lgkmcnt(0)
s_add_u32 s36, s6, s40
s_addc_u32 s37, s7, 0
s_add_u32 s44, s8, s40
s_addc_u32 s45, s9, 0
buffer_load_dwordx4 v[96:99], v1, s[36:39], s50 offen offset:0 nt
buffer_load_dwordx4 v[100:103], v1, s[36:39], s50 offen offset:1024 nt
buffer_load_dwordx4 v[104:107], v1, s[36:39], s50 offen offset:2048 nt
buffer_load_dwordx4 v[108:111], v1, s[36:39], s50 offen offset:3072 nt
s_add_u32 s50, s50, 131072
s_and_b32 s50, s50, 0x3fffff
buffer_load_dwordx4 v[112:115], v1, s[36:39], s50 offen offset:0 nt
buffer_load_dwordx4 v[116:119], v1, s[36:39], s50 offen offset:1024 nt
s_add_u32 s48, s26, 1638404
s_addc_u32 s49, s27, 0
s_load_dword s63, s[48:49], 0
s_branch L_s2
L_hstart:
s_sub_u32 s35, s28, 4
v_lshlrev_b32 v1, 4, v0
v_and_b32 v8, 7, v10
s_cmp_eq_u32 s35, 0
s_cbranch_scc0 L_h123
s_mul_i32 s40, s30, 589824
s_lshl_b32 s41, s29, 8
s_add_u32 s40, s40, s41
v_lshlrev_b32 v7, 13, v11
v_lshl_add_u32 v7, v10, 4, v7
v_add_u32 v7, s40, v7
s_mov_b32 s46, 4718592
s_mov_b32 s47, 0x20000
s_mov_b32 s42, 0
s_waitcnt lgkmcnt(0)
s_mul_i32 s40, s30, 144
v_lshl_add_u32 v2, v11, 1, s40
v_lshl_add_u32 v2, v10, 3, v2
s_mov_b32 s36, s4
s_mov_b32 s37, s5
s_mov_b32 s38, 1152
s_mov_b32 s39, 0x20000
buffer_load_dwordx4 v[16:19], v1, s[36:39], 0 offen
buffer_load_dwordx4 v[20:23], v1, s[36:39], 0 offen offset:1024
buffer_load_ushort v24, v2, s[36:39], 0 offen
buffer_load_ushort v25, v2, s[36:39], 0 offen offset:128
s_mov_b32 s44, s10
s_mov_b32 s45, s11
buffer_load_dwordx4 v[112:115], v7, s[44:47], s42 offen nt
s_add_u32 s42, s42, 0x8000
buffer_load_dwordx4 v[116:119], v7, s[44:47], s42 offen nt
s_add_u32 s42, s42, 0x8000
buffer_load_dwordx4 v[120:123], v7, s[44:47], s42 offen nt
s_add_u32 s42, s42, 0x8000
buffer_load_dwordx4 v[124:127], v7, s[44:47], s42 offen nt
s_add_u32 s42, s42, 0x8000
buffer_load_dwordx4 v[128:131], v7, s[44:47], s42 offen nt
s_add_u32 s42, s42, 0x8000
buffer_load_dwordx4 v[132:135], v7, s[44:47], s42 offen nt
s_add_u32 s42, s42, 0x8000
buffer_load_dwordx4 v[136:139], v7, s[44:47], s42 offen nt
s_add_u32 s42, s42, 0x8000
buffer_load_dwordx4 v[140:143], v7, s[44:47], s42 offen nt
s_add_u32 s42, s42, 0x8000
buffer_load_dwordx4 v[144:147], v7, s[44:47], s42 offen nt
s_add_u32 s42, s42, 0x8000
s_add_u32 s48, s26, 1638404
s_addc_u32 s49, s27, 0
s_load_dword s63, s[48:49], 0
v_and_b32 v3, 1, v10
v_lshlrev_b32 v3, 4, v3
v_mov_b32 v4, 0xffff
v_lshlrev_b32 v4, v3, v4
v_bfe_u32 v3, v10, 1, 2
v_cmp_eq_u32 vcc, 0, v3
s_nop 1
v_cndmask_b32 v12, 0, v4, vcc
v_cmp_eq_u32 vcc, 1, v3
s_nop 1
v_cndmask_b32 v13, 0, v4, vcc
v_cmp_eq_u32 vcc, 2, v3
s_nop 1
v_cndmask_b32 v14, 0, v4, vcc
v_cmp_eq_u32 vcc, 3, v3
s_nop 1
v_cndmask_b32 v15, 0, v4, vcc
v_lshlrev_b32 v5, 5, v10
v_lshl_add_u32 v5, v11, 4, v5
s_lshl_b32 s40, s31, 9
s_add_u32 s40, s40, 1507328
v_add_u32 v5, s40, v5
s_lshl_b32 s40, s29, 12
s_add_u32 s40, s40, 1507328
v_add_u32 v6, s40, v1
v_mov_b32 v9, 0
v_mov_b32 v3, -1
ds_write_b32 v9, v3 offset:640
ds_write_b32 v9, v3 offset:656
v_mov_b32 v3, 21
ds_write_b32 v9, v3 offset:672
s_waitcnt vmcnt(11)
v_lshlrev_b32 v28, 16, v16
v_and_b32 v29, 0xffff0000, v16
v_lshlrev_b32 v30, 16, v17
v_and_b32 v31, 0xffff0000, v17
v_lshlrev_b32 v32, 16, v18
v_and_b32 v33, 0xffff0000, v18
v_lshlrev_b32 v34, 16, v19
v_and_b32 v35, 0xffff0000, v19
v_lshlrev_b32 v36, 16, v20
v_and_b32 v37, 0xffff0000, v20
v_lshlrev_b32 v38, 16, v21
v_and_b32 v39, 0xffff0000, v21
v_lshlrev_b32 v40, 16, v22
v_and_b32 v41, 0xffff0000, v22
v_lshlrev_b32 v42, 16, v23
v_and_b32 v43, 0xffff0000, v23
v_add_f32 v48, v28, v36
v_add_f32 v49, v29, v37
v_add_f32 v50, v30, v38
v_add_f32 v51, v31, v39
v_add_f32 v52, v32, v40
v_add_f32 v53, v33, v41
v_add_f32 v54, v34, v42
v_add_f32 v55, v35, v43
v_add_f32 v48, v48, v52
v_add_f32 v49, v49, v53
v_add_f32 v50, v50, v54
v_add_f32 v51, v51, v55
v_add_f32 v48, v48, v50
v_add_f32 v49, v49, v51
v_add_f32 v44, v48, v49
s_nop 1
v_add_f32_dpp v44, v44, v44 row_ror:1 row_mask:0xf bank_mask:0xf
s_nop 1
v_add_f32_dpp v44, v44, v44 row_ror:2 row_mask:0xf bank_mask:0xf
s_nop 1
v_add_f32_dpp v44, v44, v44 row_ror:4 row_mask:0xf bank_mask:0xf
s_nop 1
v_add_f32_dpp v44, v44, v44 row_ror:8 row_mask:0xf bank_mask:0xf
s_nop 1
v_add_f32_dpp v44, v44, v44 row_bcast:15 row_mask:0xa bank_mask:0xf
s_nop 1
v_add_f32_dpp v44, v44, v44 row_bcast:31 row_mask:0xc bank_mask:0xf
s_nop 0
v_readlane_b32 s40, v44, 63
s_nop 1
v_mov_b32 v45, s40
v_mul_f32 v45, 0x3ae38e39, v45
v_sub_f32 v48, v28, v45
v_sub_f32 v49, v29, v45
v_sub_f32 v50, v30, v45
v_sub_f32 v51, v31, v45
v_sub_f32 v52, v32, v45
v_sub_f32 v53, v33, v45
v_sub_f32 v54, v34, v45
v_sub_f32 v55, v35, v45
v_sub_f32 v56, v36, v45
v_sub_f32 v57, v37, v45
v_sub_f32 v58, v38, v45
v_sub_f32 v59, v39, v45
v_sub_f32 v60, v40, v45
v_sub_f32 v61, v41, v45
v_sub_f32 v62, v42, v45
v_sub_f32 v63, v43, v45
v_mul_f32 v44, v48, v48
v_mul_f32 v47, v49, v49
v_fmac_f32 v44, v50, v50
v_fmac_f32 v47, v51, v51
v_fmac_f32 v44, v52, v52
v_fmac_f32 v47, v53, v53
v_fmac_f32 v44, v54, v54
v_fmac_f32 v47, v55, v55
s_mov_b64 exec, 0xff
v_fmac_f32 v44, v56, v56
v_fmac_f32 v47, v57, v57
v_fmac_f32 v44, v58, v58
v_fmac_f32 v47, v59, v59
v_fmac_f32 v44, v60, v60
v_fmac_f32 v47, v61, v61
v_fmac_f32 v44, v62, v62
v_fmac_f32 v47, v63, v63
s_mov_b64 exec, -1
v_add_f32 v44, v44, v47
s_nop 1
v_add_f32_dpp v44, v44, v44 row_ror:1 row_mask:0xf bank_mask:0xf
s_nop 1
v_add_f32_dpp v44, v44, v44 row_ror:2 row_mask:0xf bank_mask:0xf
s_nop 1
v_add_f32_dpp v44, v44, v44 row_ror:4 row_mask:0xf bank_mask:0xf
s_nop 1
v_add_f32_dpp v44, v44, v44 row_ror:8 row_mask:0xf bank_mask:0xf
s_nop 1
v_add_f32_dpp v44, v44, v44 row_bcast:15 row_mask:0xa bank_mask:0xf
s_nop 1
v_add_f32_dpp v44, v44, v44 row_bcast:31 row_mask:0xc bank_mask:0xf
s_nop 0
v_readlane_b32 s40, v44, 63
s_nop 1
v_mov_b32 v46, s40
v_mul_f32 v46, 0x3ae38e39, v46
v_cvt_pk_bf16_f32 v46, v46, v46
v_lshlrev_b32 v46, 16, v46
v_add_f32 v46, 0x3727c5ac, v46
v_cvt_pk_bf16_f32 v46, v46, v46
v_lshlrev_b32 v46, 16, v46
v_sqrt_f32 v46, v46
s_nop 0
v_cvt_pk_bf16_f32 v46, v46, v46
v_lshlrev_b32 v46, 16, v46
v_rcp_f32 v46, v46
v_cvt_pk_bf16_f32 v45, v45, v45
v_lshlrev_b32 v45, 16, v45
s_waitcnt vmcnt(9) lgkmcnt(0)
s_add_u32 s63, s63, 9
s_and_b32 s43, s63, 0x3ff
s_mov_b32 s51, 0xfffffc00
s_and_b32 s96, s63, 0xff
s_mov_b32 s97, 0xffffff00
v_lshlrev_b32 v24, 16, v24
v_sub_f32 v24, v24, v45
v_cvt_pk_bf16_f32 v24, v24, v24
v_lshlrev_b32 v24, 16, v24
v_mul_f32 v24, v24, v46
v_cvt_pk_bf16_f32 v24, v24, v24
v_lshlrev_b32 v25, 16, v25
v_sub_f32 v25, v25, v45
v_cvt_pk_bf16_f32 v25, v25, v25
v_lshlrev_b32 v25, 16, v25
v_mul_f32 v25, v25, v46
v_cvt_pk_bf16_f32 v25, v25, v25
s_getreg_b32 s58, hwreg(HW_REG_XCC_ID)
s_and_b32 s58, s58, 7
s_and_b32 s40, s63, 0xf8
s_or_b32 s58, s58, s40
v_mov_b32 v27, s58
v_and_b32_dpp v80, v24, v12 row_newbcast:0 row_mask:0xf bank_mask:0xf
v_and_b32_dpp v81, v24, v13 row_newbcast:0 row_mask:0xf bank_mask:0xf
v_and_b32_dpp v82, v24, v14 row_newbcast:0 row_mask:0xf bank_mask:0xf
v_and_b32_dpp v83, v24, v15 row_newbcast:0 row_mask:0xf bank_mask:0xf
v_and_b32_dpp v84, v24, v12 row_newbcast:1 row_mask:0xf bank_mask:0xf
v_and_b32_dpp v85, v24, v13 row_newbcast:1 row_mask:0xf bank_mask:0xf
v_and_b32_dpp v86, v24, v14 row_newbcast:1 row_mask:0xf bank_mask:0xf
v_and_b32_dpp v87, v24, v15 row_newbcast:1 row_mask:0xf bank_mask:0xf
s_waitcnt vmcnt(8)
v_mfma_f32_16x16x32_bf16 v[64:67], v[80:83], v[112:115], 0
buffer_load_dwordx4 v[148:151], v7, s[44:47], s42 offen nt
s_add_u32 s42, s42, 0x8000
v_and_b32_dpp v80, v24, v12 row_newbcast:2 row_mask:0xf bank_mask:0xf
v_and_b32_dpp v81, v24, v13 row_newbcast:2 row_mask:0xf bank_mask:0xf
v_and_b32_dpp v82, v24, v14 row_newbcast:2 row_mask:0xf bank_mask:0xf
v_and_b32_dpp v83, v24, v15 row_newbcast:2 row_mask:0xf bank_mask:0xf
s_waitcnt vmcnt(8)
v_mfma_f32_16x16x32_bf16 v[64:67], v[84:87], v[116:119], v[64:67]
buffer_load_dwordx4 v[152:155], v7, s[44:47], s42 offen nt
s_add_u32 s42, s42, 0x8000
v_and_b32_dpp v84, v24, v12 row_newbcast:3 row_mask:0xf bank_mask:0xf
v_and_b32_dpp v85, v24, v13 row_newbcast:3 row_mask:0xf bank_mask:0xf
v_and_b32_dpp v86, v24, v14 row_newbcast:3 row_mask:0xf bank_mask:0xf
v_and_b32_dpp v87, v24, v15 row_newbcast:3 row_mask:0xf bank_mask:0xf
s_waitcnt vmcnt(8)
v_mfma_f32_16x16x32_bf16 v[64:67], v[80:83], v[120:123], v[64:67]
buffer_load_dwordx4 v[156:159], v7, s[44:47], s42 offen nt
s_add_u32 s42, s42, 0x8000
v_and_b32_dpp v80, v24, v12 row_newbcast:4 row_mask:0xf bank_mask:0xf
v_and_b32_dpp v81, v24, v13 row_newbcast:4 row_mask:0xf bank_mask:0xf
v_and_b32_dpp v82, v24, v14 row_newbcast:4 row_mask:0xf bank_mask:0xf
v_and_b32_dpp v83, v24, v15 row_newbcast:4 row_mask:0xf bank_mask:0xf
s_waitcnt vmcnt(8)
v_mfma_f32_16x16x32_bf16 v[64:67], v[84:87], v[124:127], v[64:67]
buffer_load_dwordx4 v[160:163], v7, s[44:47], s42 offen nt
s_add_u32 s42, s42, 0x8000
v_and_b32_dpp v84, v24, v12 row_newbcast:5 row_mask:0xf bank_mask:0xf
v_and_b32_dpp v85, v24, v13 row_newbcast:5 row_mask:0xf bank_mask:0xf
v_and_b32_dpp v86, v24, v14 row_newbcast:5 row_mask:0xf bank_mask:0xf
v_and_b32_dpp v87, v24, v15 row_newbcast:5 row_mask:0xf bank_mask:0xf
s_waitcnt vmcnt(8)
v_mfma_f32_16x16x32_bf16 v[64:67], v[80:83], v[128:131], v[64:67]
buffer_load_dwordx4 v[164:167], v7, s[44:47], s42 offen nt
s_add_u32 s42, s42, 0x8000
v_and_b32_dpp v80, v24, v12 row_newbcast:6 row_mask:0xf bank_mask:0xf
v_and_b32_dpp v81, v24, v13 row_newbcast:6 row_mask:0xf bank_mask:0xf
v_and_b32_dpp v82, v24, v14 row_newbcast:6 row_mask:0xf bank_mask:0xf
v_and_b32_dpp v83, v24, v15 row_newbcast:6 row_mask:0xf bank_mask:0xf
s_waitcnt vmcnt(8)
v_mfma_f32_16x16x32_bf16 v[64:67], v[84:87], v[132:135], v[64:67]
buffer_load_dwordx4 v[168:171], v7, s[44:47], s42 offen nt
s_add_u32 s42, s42, 0x8000
v_and_b32_dpp v84, v24, v12 row_newbcast:7 row_mask:0xf bank_mask:0xf
v_and_b32_dpp v85, v24, v13 row_newbcast:7 row_mask:0xf bank_mask:0xf
v_and_b32_dpp v86, v24, v14 row_newbcast:7 row_mask:0xf bank_mask:0xf
v_and_b32_dpp v87, v24, v15 row_newbcast:7 row_mask:0xf bank_mask:0xf
s_waitcnt vmcnt(8)
v_mfma_f32_16x16x32_bf16 v[64:67], v[80:83], v[136:139], v[64:67]
buffer_load_dwordx4 v[172:175], v7, s[44:47], s42 offen nt
s_add_u32 s42, s42, 0x8000
v_and_b32_dpp v80, v24, v12 row_newbcast:8 row_mask:0xf bank_mask:0xf
v_and_b32_dpp v81, v24, v13 row_newbcast:8 row_mask:0xf bank_mask:0xf
v_and_b32_dpp v82, v24, v14 row_newbcast:8 row_mask:0xf bank_mask:0xf
v_and_b32_dpp v83, v24, v15 row_newbcast:8 row_mask:0xf bank_mask:0xf
s_waitcnt vmcnt(8)
v_mfma_f32_16x16x32_bf16 v[64:67], v[84:87], v[140:143], v[64:67]
buffer_load_dwordx4 v[176:179], v7, s[44:47], s42 offen nt
s_add_u32 s42, s42, 0x8000
v_and_b32_dpp v84, v24, v12 row_newbcast:9 row_mask:0xf bank_mask:0xf
v_and_b32_dpp v85, v24, v13 row_newbcast:9 row_mask:0xf bank_mask:0xf
v_and_b32_dpp v86, v24, v14 row_newbcast:9 row_mask:0xf bank_mask:0xf
v_and_b32_dpp v87, v24, v15 row_newbcast:9 row_mask:0xf bank_mask:0xf
s_waitcnt vmcnt(8)
v_mfma_f32_16x16x32_bf16 v[64:67], v[80:83], v[144:147], v[64:67]
buffer_load_dwordx4 v[180:183], v7, s[44:47], s42 offen nt
v_and_b32_dpp v80, v24, v12 row_newbcast:10 row_mask:0xf bank_mask:0xf
v_and_b32_dpp v81, v24, v13 row_newbcast:10 row_mask:0xf bank_mask:0xf
v_and_b32_dpp v82, v24, v14 row_newbcast:10 row_mask:0xf bank_mask:0xf
v_and_b32_dpp v83, v24, v15 row_newbcast:10 row_mask:0xf bank_mask:0xf
s_waitcnt vmcnt(8)
v_mfma_f32_16x16x32_bf16 v[64:67], v[84:87], v[148:151], v[64:67]
v_and_b32_dpp v84, v24, v12 row_newbcast:11 row_mask:0xf bank_mask:0xf
v_and_b32_dpp v85, v24, v13 row_newbcast:11 row_mask:0xf bank_mask:0xf
v_and_b32_dpp v86, v24, v14 row_newbcast:11 row_mask:0xf bank_mask:0xf
v_and_b32_dpp v87, v24, v15 row_newbcast:11 row_mask:0xf bank_mask:0xf
s_waitcnt vmcnt(7)
v_mfma_f32_16x16x32_bf16 v[64:67], v[80:83], v[152:155], v[64:67]
v_and_b32_dpp v80, v24, v12 row_newbcast:12 row_mask:0xf bank_mask:0xf
v_and_b32_dpp v81, v24, v13 row_newbcast:12 row_mask:0xf bank_mask:0xf
v_and_b32_dpp v82, v24, v14 row_newbcast:12 row_mask:0xf bank_mask:0xf
v_and_b32_dpp v83, v24, v15 row_newbcast:12 row_mask:0xf bank_mask:0xf
s_waitcnt vmcnt(6)
v_mfma_f32_16x16x32_bf16 v[64:67], v[84:87], v[156:159], v[64:67]
v_and_b32_dpp v84, v24, v12 row_newbcast:13 row_mask:0xf bank_mask:0xf
v_and_b32_dpp v85, v24, v13 row_newbcast:13 row_mask:0xf bank_mask:0xf
v_and_b32_dpp v86, v24, v14 row_newbcast:13 row_mask:0xf bank_mask:0xf
v_and_b32_dpp v87, v24, v15 row_newbcast:13 row_mask:0xf bank_mask:0xf
s_waitcnt vmcnt(5)
v_mfma_f32_16x16x32_bf16 v[64:67], v[80:83], v[160:163], v[64:67]
v_and_b32_dpp v80, v24, v12 row_newbcast:14 row_mask:0xf bank_mask:0xf
v_and_b32_dpp v81, v24, v13 row_newbcast:14 row_mask:0xf bank_mask:0xf
v_and_b32_dpp v82, v24, v14 row_newbcast:14 row_mask:0xf bank_mask:0xf
v_and_b32_dpp v83, v24, v15 row_newbcast:14 row_mask:0xf bank_mask:0xf
s_waitcnt vmcnt(4)
v_mfma_f32_16x16x32_bf16 v[64:67], v[84:87], v[164:167], v[64:67]
v_and_b32_dpp v84, v24, v12 row_newbcast:15 row_mask:0xf bank_mask:0xf
v_and_b32_dpp v85, v24, v13 row_newbcast:15 row_mask:0xf bank_mask:0xf
v_and_b32_dpp v86, v24, v14 row_newbcast:15 row_mask:0xf bank_mask:0xf
v_and_b32_dpp v87, v24, v15 row_newbcast:15 row_mask:0xf bank_mask:0xf
s_waitcnt vmcnt(3)
v_mfma_f32_16x16x32_bf16 v[64:67], v[80:83], v[168:171], v[64:67]
v_and_b32_dpp v80, v25, v12 row_newbcast:0 row_mask:0xf bank_mask:0xf
v_and_b32_dpp v81, v25, v13 row_newbcast:0 row_mask:0xf bank_mask:0xf
v_and_b32_dpp v82, v25, v14 row_newbcast:0 row_mask:0xf bank_mask:0xf
v_and_b32_dpp v83, v25, v15 row_newbcast:0 row_mask:0xf bank_mask:0xf
s_waitcnt vmcnt(2)
v_mfma_f32_16x16x32_bf16 v[64:67], v[84:87], v[172:175], v[64:67]
v_and_b32_dpp v84, v25, v12 row_newbcast:1 row_mask:0xf bank_mask:0xf
v_and_b32_dpp v85, v25, v13 row_newbcast:1 row_mask:0xf bank_mask:0xf
v_and_b32_dpp v86, v25, v14 row_newbcast:1 row_mask:0xf bank_mask:0xf
v_and_b32_dpp v87, v25, v15 row_newbcast:1 row_mask:0xf bank_mask:0xf
s_waitcnt vmcnt(1)
v_mfma_f32_16x16x32_bf16 v[64:67], v[80:83], v[176:179], v[64:67]
s_nop 1
s_waitcnt vmcnt(0)
v_mfma_f32_16x16x32_bf16 v[64:67], v[84:87], v[180:183], v[64:67]
s_mov_b32 exec_hi, 0
s_nop 6
v_and_or_b32 v64, v64, s97, v27
v_and_or_b32 v65, v65, s97, v27
v_and_or_b32 v66, v66, s97, v27
v_and_or_b32 v67, v67, s97, v27
global_store_dwordx4 v5, v[64:67], s[26:27]
s_mov_b64 exec, -1
s_mov_b32 s41, 12
s_sleep 8
L_qpoll:
s_cmp_eq_u32 s41, 0
s_cbranch_scc1 L_lw1
global_load_dwordx4 v[112:115], v6, s[26:27] offset:0 nt
global_load_dwordx4 v[116:119], v6, s[26:27] offset:1024 nt
global_load_dwordx4 v[120:123], v6, s[26:27] offset:2048 nt
global_load_dwordx4 v[124:127], v6, s[26:27] offset:3072 nt
s_branch L_ld2
L_lw1:
global_load_dwordx4 v[112:115], v6, s[26:27] offset:0 sc1
global_load_dwordx4 v[116:119], v6, s[26:27] offset:1024 sc1
global_load_dwordx4 v[120:123], v6, s[26:27] offset:2048 sc1
global_load_dwordx4 v[124:127], v6, s[26:27] offset:3072 sc1
L_ld2:
s_waitcnt vmcnt(0)
v_xor_b32 v112, s58, v112
v_xor_b32 v113, s58, v113
v_xor_b32 v114, s58, v114
v_xor_b32 v115, s58, v115
v_xor_b32 v116, s58, v116
v_xor_b32 v117, s58, v117
v_xor_b32 v118, s58, v118
v_xor_b32 v119, s58, v119
v_xor_b32 v120, s58, v120
v_xor_b32 v121, s58, v121
v_xor_b32 v122, s58, v122
v_xor_b32 v123, s58, v123
v_xor_b32 v124, s58, v124
v_xor_b32 v125, s58, v125
v_xor_b32 v126, s58, v126
v_xor_b32 v127, s58, v127
v_or3_b32 v3, v112, v113, v114
v_or3_b32 v3, v3, v115, v116
v_or3_b32 v3, v3, v117, v118
v_or3_b32 v3, v3, v119, v120
v_or3_b32 v3, v3, v121, v122
v_or3_b32 v3, v3, v123, v124
v_or3_b32 v3, v3, v125, v126
v_or_b32 v3, v3, v127
v_and_b32 v4, 0xf8, v3
v_cmp_ne_u32 vcc, 0, v4
s_cbranch_vccz L_qdone
s_sleep 4
s_cmp_eq_u32 s41, 0
s_cbranch_scc1 L_qpoll3
s_sub_u32 s41, s41, 1
s_cmp_lg_u32 s41, 0
s_cbranch_scc1 L_qpoll2
buffer_wbl2 sc1
s_waitcnt vmcnt(0)
L_qpoll3:
buffer_inv sc1
s_waitcnt vmcnt(0)
L_qpoll2:
s_sub_u32 s94, s94, 1
s_cbranch_scc0 L_qpoll
L_qdone:
v_and_b32 v4, 7, v3
v_cmp_ne_u32 vcc, 0, v4
v_and_b32 v112, s97, v112
v_and_b32 v113, s97, v113
v_and_b32 v114, s97, v114
v_and_b32 v115, s97, v115
v_and_b32 v116, s97, v116
v_and_b32 v117, s97, v117
v_and_b32 v118, s97, v118
v_and_b32 v119, s97, v119
v_and_b32 v120, s97, v120
v_and_b32 v121, s97, v121
v_and_b32 v122, s97, v122
v_and_b32 v123, s97, v123
v_and_b32 v124, s97, v124
v_and_b32 v125, s97, v125
v_and_b32 v126, s97, v126
v_and_b32 v127, s97, v127
s_cmp_eq_u64 vcc, 0
s_cselect_b32 s40, 1, 0
s_cbranch_scc1 L_qloc
buffer_wbl2 sc1
s_waitcnt vmcnt(0)
L_qloc:
v_add_f32 v112, v112, v116
v_add_f32 v120, v120, v124
v_add_f32 v113, v113, v117
v_add_f32 v121, v121, v125
v_add_f32 v114, v114, v118
v_add_f32 v122, v122, v126
v_add_f32 v115, v115, v119
v_add_f32 v123, v123, v127
v_add_f32 v112, v112, v120
v_add_f32 v113, v113, v121
v_add_f32 v114, v114, v122
v_add_f32 v115, v115, v123
v_mov_b32 v116, v112
v_mov_b32 v117, v113
v_mov_b32 v118, v114
v_mov_b32 v119, v115
v_and_b32 v4, 31, v0
v_lshlrev_b32 v4, 3, v4
v_permlane32_swap_b32 v116, v112
v_permlane32_swap_b32 v117, v113
v_permlane32_swap_b32 v118, v114
v_permlane32_swap_b32 v119, v115
v_add_f32 v112, v116, v112
v_add_f32 v113, v117, v113
v_add_f32 v114, v118, v114
v_add_f32 v115, v119, v115
v_cvt_pk_bf16_f32 v120, v112, v113
v_cvt_pk_bf16_f32 v121, v114, v115
ds_write_b64 v4, v[120:121] offset:0
v_mov_b32 v3, s40
v_mov_b32 v4, 0
ds_write_b32 v4, v3 offset:608
s_waitcnt lgkmcnt(0)
s_barrier
v_mov_b32 v9, 0
s_lshl_b32 s40, s33, 8
s_add_u32 s40, s40, 1703936
v_lshl_add_u32 v5, v0, 2, s40
s_add_u32 s46, s40, 128
v_mov_b32 v7, s46
s_lshl_b32 s42, s34, 2
s_add_u32 s40, s40, s42
v_mov_b32 v6, s40
s_lshl_b32 s40, s33, 7
s_add_u32 s40, s40, 1769472
v_mov_b32 v26, s40
v_lshlrev_b32 v2, 7, v0
v_add_u32 v2, 0x1b0000, v2
s_mov_b32 s41, 0
s_lshl_b32 s44, s63, 5
s_and_b32 s60, s58, 1
s_mul_i32 s60, s60, 0
L_fb:
ds_read_b32 v3, v9 offset:640
s_waitcnt lgkmcnt(0)
v_readfirstlane_b32 s40, v3
s_cmp_ge_i32 s40, s41
s_cbranch_scc1 L_fb2
s_sleep 4
s_sub_u32 s94, s94, 1
s_cbranch_scc0 L_fb
s_branch L_hC
L_fb2:
s_add_u32 s45, s44, s41
v_mov_b32 v4, s45
s_mov_b32 exec_hi, 0
global_load_dword v3, v5, s[26:27] nt
s_mov_b64 exec, 1
global_store_dword v6, v4, s[26:27]
s_mov_b32 exec_lo, -1
s_waitcnt vmcnt(1)
v_sub_u32 v3, v3, v4
v_cmp_gt_u32 vcc, 32, v3
s_bcnt1_i32_b64 s42, vcc
s_mov_b64 exec, 1
s_mul_i32 s40, s42, 6
s_lshr_b32 s40, s40, 5
s_add_u32 s40, s40, 20
v_mov_b32 v3, s40
ds_write_b32 v9, v3 offset:672
s_mov_b64 exec, -1
s_add_u32 s41, s41, 1
s_cmp_lt_u32 s41, 12
s_cbranch_scc1 L_fb
s_branch L_hC
L_h123:
s_waitcnt lgkmcnt(0)
s_add_u32 s48, s26, 1638404
s_addc_u32 s49, s27, 0
s_load_dword s63, s[48:49], 0
s_cmp_eq_u32 s35, 3
s_cbranch_scc1 L_h3
s_and_b32 s56, s29, 3
s_mov_b32 s57, 1
v_mov_b32 v9, v10
s_cmp_eq_u32 s35, 1
s_cbranch_scc1 L_gu
s_cmp_eq_u32 s56, 0
s_mov_b32 s56, 4
s_mov_b32 s57, 0
v_mov_b32 v9, v8
s_cbranch_scc1 L_gu
v_and_b32 v3, 1, v10
v_lshlrev_b32 v3, 4, v3
v_mov_b32 v4, 0xffff
v_lshlrev_b32 v4, v3, v4
v_bfe_u32 v3, v10, 1, 2
v_cmp_eq_u32 vcc, 0, v3
s_nop 1
v_cndmask_b32 v12, 0, v4, vcc
v_cmp_eq_u32 vcc, 1, v3
s_nop 1
v_cndmask_b32 v13, 0, v4, vcc
v_cmp_eq_u32 vcc, 2, v3
s_nop 1
v_cndmask_b32 v14, 0, v4, vcc
v_cmp_eq_u32 vcc, 3, v3
s_nop 1
v_cndmask_b32 v15, 0, v4, vcc
s_waitcnt lgkmcnt(0)
s_add_u32 s63, s63, 9
s_and_b32 s43, s63, 0x3ff
s_mov_b32 s51, 0xfffffc00
s_and_b32 s96, s63, 0xff
s_mov_b32 s97, 0xffffff00
s_barrier
s_branch L_hC
L_gu:
s_mul_i32 s40, s30, 144
v_lshl_add_u32 v2, v11, 1, s40
v_lshl_add_u32 v2, v10, 3, v2
s_mov_b32 s36, s4
s_mov_b32 s37, s5
s_mov_b32 s38, 1152
s_mov_b32 s39, 0x20000
buffer_load_dwordx4 v[16:19], v1, s[36:39], 0 offen
buffer_load_dwordx4 v[20:23], v1, s[36:39], 0 offen offset:1024
buffer_load_ushort v24, v2, s[36:39], 0 offen
buffer_load_ushort v25, v2, s[36:39], 0 offen offset:128
v_and_b32 v3, 1, v10
v_lshlrev_b32 v3, 4, v3
v_mov_b32 v4, 0xffff
v_lshlrev_b32 v4, v3, v4
v_bfe_u32 v3, v10, 1, 2
v_cmp_eq_u32 vcc, 0, v3
s_nop 1
v_cndmask_b32 v12, 0, v4, vcc
v_cmp_eq_u32 vcc, 1, v3
s_nop 1
v_cndmask_b32 v13, 0, v4, vcc
v_cmp_eq_u32 vcc, 2, v3
s_nop 1
v_cndmask_b32 v14, 0, v4, vcc
v_cmp_eq_u32 vcc, 3, v3
s_nop 1
v_cndmask_b32 v15, 0, v4, vcc
s_waitcnt vmcnt(2)
v_lshlrev_b32 v28, 16, v16
v_and_b32 v29, 0xffff0000, v16
v_lshlrev_b32 v30, 16, v17
v_and_b32 v31, 0xffff0000, v17
v_lshlrev_b32 v32, 16, v18
v_and_b32 v33, 0xffff0000, v18
v_lshlrev_b32 v34, 16, v19
v_and_b32 v35, 0xffff0000, v19
v_lshlrev_b32 v36, 16, v20
v_and_b32 v37, 0xffff0000, v20
v_lshlrev_b32 v38, 16, v21
v_and_b32 v39, 0xffff0000, v21
v_lshlrev_b32 v40, 16, v22
v_and_b32 v41, 0xffff0000, v22
v_lshlrev_b32 v42, 16, v23
v_and_b32 v43, 0xffff0000, v23
v_add_f32 v48, v28, v36
v_add_f32 v49, v29, v37
v_add_f32 v50, v30, v38
v_add_f32 v51, v31, v39
v_add_f32 v52, v32, v40
v_add_f32 v53, v33, v41
v_add_f32 v54, v34, v42
v_add_f32 v55, v35, v43
v_add_f32 v48, v48, v52
v_add_f32 v49, v49, v53
v_add_f32 v50, v50, v54
v_add_f32 v51, v51, v55
v_add_f32 v48, v48, v50
v_add_f32 v49, v49, v51
v_add_f32 v44, v48, v49
s_nop 1
v_add_f32_dpp v44, v44, v44 row_ror:1 row_mask:0xf bank_mask:0xf
s_nop 1
v_add_f32_dpp v44, v44, v44 row_ror:2 row_mask:0xf bank_mask:0xf
s_nop 1
v_add_f32_dpp v44, v44, v44 row_ror:4 row_mask:0xf bank_mask:0xf
s_nop 1
v_add_f32_dpp v44, v44, v44 row_ror:8 row_mask:0xf bank_mask:0xf
s_nop 1
v_add_f32_dpp v44, v44, v44 row_bcast:15 row_mask:0xa bank_mask:0xf
s_nop 1
v_add_f32_dpp v44, v44, v44 row_bcast:31 row_mask:0xc bank_mask:0xf
s_nop 0
v_readlane_b32 s40, v44, 63
s_nop 1
v_mov_b32 v45, s40
v_mul_f32 v45, 0x3ae38e39, v45
v_sub_f32 v48, v28, v45
v_sub_f32 v49, v29, v45
v_sub_f32 v50, v30, v45
v_sub_f32 v51, v31, v45
v_sub_f32 v52, v32, v45
v_sub_f32 v53, v33, v45
v_sub_f32 v54, v34, v45
v_sub_f32 v55, v35, v45
v_sub_f32 v56, v36, v45
v_sub_f32 v57, v37, v45
v_sub_f32 v58, v38, v45
v_sub_f32 v59, v39, v45
v_sub_f32 v60, v40, v45
v_sub_f32 v61, v41, v45
v_sub_f32 v62, v42, v45
v_sub_f32 v63, v43, v45
v_mul_f32 v44, v48, v48
v_mul_f32 v47, v49, v49
v_fmac_f32 v44, v50, v50
v_fmac_f32 v47, v51, v51
v_fmac_f32 v44, v52, v52
v_fmac_f32 v47, v53, v53
v_fmac_f32 v44, v54, v54
v_fmac_f32 v47, v55, v55
s_mov_b64 exec, 0xff
v_fmac_f32 v44, v56, v56
v_fmac_f32 v47, v57, v57
v_fmac_f32 v44, v58, v58
v_fmac_f32 v47, v59, v59
v_fmac_f32 v44, v60, v60
v_fmac_f32 v47, v61, v61
v_fmac_f32 v44, v62, v62
v_fmac_f32 v47, v63, v63
s_mov_b64 exec, -1
v_add_f32 v44, v44, v47
s_nop 1
v_add_f32_dpp v44, v44, v44 row_ror:1 row_mask:0xf bank_mask:0xf
s_nop 1
v_add_f32_dpp v44, v44, v44 row_ror:2 row_mask:0xf bank_mask:0xf
s_nop 1
v_add_f32_dpp v44, v44, v44 row_ror:4 row_mask:0xf bank_mask:0xf
s_nop 1
v_add_f32_dpp v44, v44, v44 row_ror:8 row_mask:0xf bank_mask:0xf
s_nop 1
v_add_f32_dpp v44, v44, v44 row_bcast:15 row_mask:0xa bank_mask:0xf
s_nop 1
v_add_f32_dpp v44, v44, v44 row_bcast:31 row_mask:0xc bank_mask:0xf
s_nop 0
v_readlane_b32 s40, v44, 63
s_nop 1
v_mov_b32 v46, s40
v_mul_f32 v46, 0x3ae38e39, v46
v_cvt_pk_bf16_f32 v46, v46, v46
v_lshlrev_b32 v46, 16, v46
v_add_f32 v46, 0x3727c5ac, v46
v_cvt_pk_bf16_f32 v46, v46, v46
v_lshlrev_b32 v46, 16, v46
v_sqrt_f32 v46, v46
s_nop 0
v_cvt_pk_bf16_f32 v46, v46, v46
v_lshlrev_b32 v46, 16, v46
v_rcp_f32 v46, v46
v_cvt_pk_bf16_f32 v45, v45, v45
v_lshlrev_b32 v45, 16, v45
s_waitcnt vmcnt(0) lgkmcnt(0)
s_add_u32 s63, s63, 9
s_and_b32 s43, s63, 0x3ff
s_mov_b32 s51, 0xfffffc00
s_and_b32 s96, s63, 0xff
s_mov_b32 s97, 0xffffff00
v_lshlrev_b32 v24, 16, v24
v_sub_f32 v24, v24, v45
v_cvt_pk_bf16_f32 v24, v24, v24
v_lshlrev_b32 v24, 16, v24
v_mul_f32 v24, v24, v46
v_cvt_pk_bf16_f32 v24, v24, v24
v_lshlrev_b32 v25, 16, v25
v_sub_f32 v25, v25, v45
v_cvt_pk_bf16_f32 v25, v25, v25
v_lshlrev_b32 v25, 16, v25
v_mul_f32 v25, v25, v46
v_cvt_pk_bf16_f32 v25, v25, v25
s_barrier
s_mul_i32 s40, s33, 1152
s_lshl_b32 s41, s56, 8
s_add_u32 s40, s40, s41
s_add_u32 s44, s16, s40
s_addc_u32 s45, s17, 0
s_sub_u32 s46, 5308416, s40
s_mov_b32 s47, 0x20000
s_add_u32 s52, s18, s40
s_addc_u32 s53, s19, 0
s_mov_b32 s54, s46
s_mov_b32 s55, 0x20000
s_mul_i32 s40, s30, 663552
s_mov_b32 s42, 9216
v_mul_lo_u32 v6, v11, s42
v_lshl_add_u32 v6, v9, 4, v6
v_add_u32 v6, s40, v6
s_mov_b32 s42, 0
buffer_load_dwordx4 v[112:115], v6, s[44:47], s42 offen nt
buffer_load_dwordx4 v[116:119], v6, s[52:55], s42 offen nt
v_mov_b32 v27, s96
v_and_b32_dpp v80, v24, v12 row_newbcast:0 row_mask:0xf bank_mask:0xf
v_and_b32_dpp v81, v24, v13 row_newbcast:0 row_mask:0xf bank_mask:0xf
v_and_b32_dpp v82, v24, v14 row_newbcast:0 row_mask:0xf bank_mask:0xf
v_and_b32_dpp v83, v24, v15 row_newbcast:0 row_mask:0xf bank_mask:0xf
v_and_b32_dpp v84, v24, v12 row_newbcast:1 row_mask:0xf bank_mask:0xf
v_and_b32_dpp v85, v24, v13 row_newbcast:1 row_mask:0xf bank_mask:0xf
v_and_b32_dpp v86, v24, v14 row_newbcast:1 row_mask:0xf bank_mask:0xf
v_and_b32_dpp v87, v24, v15 row_newbcast:1 row_mask:0xf bank_mask:0xf
s_waitcnt vmcnt(1)
v_mfma_f32_16x16x32_bf16 v[64:67], v[80:83], v[112:115], 0
s_mov_b32 s42, 36864
buffer_load_dwordx4 v[120:123], v6, s[44:47], s42 offen nt
s_waitcnt vmcnt(1)
v_mfma_f32_16x16x32_bf16 v[68:71], v[80:83], v[116:119], 0
buffer_load_dwordx4 v[124:127], v6, s[52:55], s42 offen nt
v_and_b32_dpp v80, v24, v12 row_newbcast:2 row_mask:0xf bank_mask:0xf
v_and_b32_dpp v81, v24, v13 row_newbcast:2 row_mask:0xf bank_mask:0xf
v_and_b32_dpp v82, v24, v14 row_newbcast:2 row_mask:0xf bank_mask:0xf
v_and_b32_dpp v83, v24, v15 row_newbcast:2 row_mask:0xf bank_mask:0xf
s_waitcnt vmcnt(1)
v_mfma_f32_16x16x32_bf16 v[64:67], v[84:87], v[120:123], v[64:67]
s_mov_b32 s42, 73728
buffer_load_dwordx4 v[128:131], v6, s[44:47], s42 offen nt
s_waitcnt vmcnt(1)
v_mfma_f32_16x16x32_bf16 v[68:71], v[84:87], v[124:127], v[68:71]
buffer_load_dwordx4 v[132:135], v6, s[52:55], s42 offen nt
v_and_b32_dpp v84, v24, v12 row_newbcast:3 row_mask:0xf bank_mask:0xf
v_and_b32_dpp v85, v24, v13 row_newbcast:3 row_mask:0xf bank_mask:0xf
v_and_b32_dpp v86, v24, v14 row_newbcast:3 row_mask:0xf bank_mask:0xf
v_and_b32_dpp v87, v24, v15 row_newbcast:3 row_mask:0xf bank_mask:0xf
s_waitcnt vmcnt(1)
v_mfma_f32_16x16x32_bf16 v[64:67], v[80:83], v[128:131], v[64:67]
s_mov_b32 s42, 110592
buffer_load_dwordx4 v[136:139], v6, s[44:47], s42 offen nt
s_waitcnt vmcnt(1)
v_mfma_f32_16x16x32_bf16 v[68:71], v[80:83], v[132:135], v[68:71]
buffer_load_dwordx4 v[140:143], v6, s[52:55], s42 offen nt
v_and_b32_dpp v80, v24, v12 row_newbcast:4 row_mask:0xf bank_mask:0xf
v_and_b32_dpp v81, v24, v13 row_newbcast:4 row_mask:0xf bank_mask:0xf
v_and_b32_dpp v82, v24, v14 row_newbcast:4 row_mask:0xf bank_mask:0xf
v_and_b32_dpp v83, v24, v15 row_newbcast:4 row_mask:0xf bank_mask:0xf
s_waitcnt vmcnt(1)
v_mfma_f32_16x16x32_bf16 v[64:67], v[84:87], v[136:139], v[64:67]
s_mov_b32 s42, 147456
buffer_load_dwordx4 v[144:147], v6, s[44:47], s42 offen nt
s_waitcnt vmcnt(1)
v_mfma_f32_16x16x32_bf16 v[68:71], v[84:87], v[140:143], v[68:71]
buffer_load_dwordx4 v[148:151], v6, s[52:55], s42 offen nt
v_and_b32_dpp v84, v24, v12 row_newbcast:5 row_mask:0xf bank_mask:0xf
v_and_b32_dpp v85, v24, v13 row_newbcast:5 row_mask:0xf bank_mask:0xf
v_and_b32_dpp v86, v24, v14 row_newbcast:5 row_mask:0xf bank_mask:0xf
v_and_b32_dpp v87, v24, v15 row_newbcast:5 row_mask:0xf bank_mask:0xf
s_waitcnt vmcnt(1)
v_mfma_f32_16x16x32_bf16 v[64:67], v[80:83], v[144:147], v[64:67]
s_mov_b32 s42, 184320
buffer_load_dwordx4 v[152:155], v6, s[44:47], s42 offen nt
s_waitcnt vmcnt(1)
v_mfma_f32_16x16x32_bf16 v[68:71], v[80:83], v[148:151], v[68:71]
buffer_load_dwordx4 v[156:159], v6, s[52:55], s42 offen nt
v_and_b32_dpp v80, v24, v12 row_newbcast:6 row_mask:0xf bank_mask:0xf
v_and_b32_dpp v81, v24, v13 row_newbcast:6 row_mask:0xf bank_mask:0xf
v_and_b32_dpp v82, v24, v14 row_newbcast:6 row_mask:0xf bank_mask:0xf
v_and_b32_dpp v83, v24, v15 row_newbcast:6 row_mask:0xf bank_mask:0xf
s_waitcnt vmcnt(1)
v_mfma_f32_16x16x32_bf16 v[64:67], v[84:87], v[152:155], v[64:67]
s_mov_b32 s42, 221184
buffer_load_dwordx4 v[160:163], v6, s[44:47], s42 offen nt
s_waitcnt vmcnt(1)
v_mfma_f32_16x16x32_bf16 v[68:71], v[84:87], v[156:159], v[68:71]
buffer_load_dwordx4 v[164:167], v6, s[52:55], s42 offen nt
v_and_b32_dpp v84, v24, v12 row_newbcast:7 row_mask:0xf bank_mask:0xf
v_and_b32_dpp v85, v24, v13 row_newbcast:7 row_mask:0xf bank_mask:0xf
v_and_b32_dpp v86, v24, v14 row_newbcast:7 row_mask:0xf bank_mask:0xf
v_and_b32_dpp v87, v24, v15 row_newbcast:7 row_mask:0xf bank_mask:0xf
s_waitcnt vmcnt(1)
v_mfma_f32_16x16x32_bf16 v[64:67], v[80:83], v[160:163], v[64:67]
s_mov_b32 s42, 258048
buffer_load_dwordx4 v[168:171], v6, s[44:47], s42 offen nt
s_waitcnt vmcnt(1)
v_mfma_f32_16x16x32_bf16 v[68:71], v[80:83], v[164:167], v[68:71]
buffer_load_dwordx4 v[172:175], v6, s[52:55], s42 offen nt
v_and_b32_dpp v80, v24, v12 row_newbcast:8 row_mask:0xf bank_mask:0xf
v_and_b32_dpp v81, v24, v13 row_newbcast:8 row_mask:0xf bank_mask:0xf
v_and_b32_dpp v82, v24, v14 row_newbcast:8 row_mask:0xf bank_mask:0xf
v_and_b32_dpp v83, v24, v15 row_newbcast:8 row_mask:0xf bank_mask:0xf
s_waitcnt vmcnt(1)
v_mfma_f32_16x16x32_bf16 v[64:67], v[84:87], v[168:171], v[64:67]
s_mov_b32 s42, 294912
buffer_load_dwordx4 v[176:179], v6, s[44:47], s42 offen nt
s_waitcnt vmcnt(1)
v_mfma_f32_16x16x32_bf16 v[68:71], v[84:87], v[172:175], v[68:71]
buffer_load_dwordx4 v[180:183], v6, s[52:55], s42 offen nt
v_and_b32_dpp v84, v24, v12 row_newbcast:9 row_mask:0xf bank_mask:0xf
v_and_b32_dpp v85, v24, v13 row_newbcast:9 row_mask:0xf bank_mask:0xf
v_and_b32_dpp v86, v24, v14 row_newbcast:9 row_mask:0xf bank_mask:0xf
v_and_b32_dpp v87, v24, v15 row_newbcast:9 row_mask:0xf bank_mask:0xf
s_waitcnt vmcnt(1)
v_mfma_f32_16x16x32_bf16 v[64:67], v[80:83], v[176:179], v[64:67]
s_mov_b32 s42, 331776
buffer_load_dwordx4 v[184:187], v6, s[44:47], s42 offen nt
s_waitcnt vmcnt(1)
v_mfma_f32_16x16x32_bf16 v[68:71], v[80:83], v[180:183], v[68:71]
buffer_load_dwordx4 v[188:191], v6, s[52:55], s42 offen nt
v_and_b32_dpp v80, v24, v12 row_newbcast:10 row_mask:0xf bank_mask:0xf
v_and_b32_dpp v81, v24, v13 row_newbcast:10 row_mask:0xf bank_mask:0xf
v_and_b32_dpp v82, v24, v14 row_newbcast:10 row_mask:0xf bank_mask:0xf
v_and_b32_dpp v83, v24, v15 row_newbcast:10 row_mask:0xf bank_mask:0xf
s_waitcnt vmcnt(1)
v_mfma_f32_16x16x32_bf16 v[64:67], v[84:87], v[184:187], v[64:67]
s_mov_b32 s42, 368640
buffer_load_dwordx4 v[192:195], v6, s[44:47], s42 offen nt
s_waitcnt vmcnt(1)
v_mfma_f32_16x16x32_bf16 v[68:71], v[84:87], v[188:191], v[68:71]
buffer_load_dwordx4 v[196:199], v6, s[52:55], s42 offen nt
v_and_b32_dpp v84, v24, v12 row_newbcast:11 row_mask:0xf bank_mask:0xf
v_and_b32_dpp v85, v24, v13 row_newbcast:11 row_mask:0xf bank_mask:0xf
v_and_b32_dpp v86, v24, v14 row_newbcast:11 row_mask:0xf bank_mask:0xf
v_and_b32_dpp v87, v24, v15 row_newbcast:11 row_mask:0xf bank_mask:0xf
s_waitcnt vmcnt(1)
v_mfma_f32_16x16x32_bf16 v[64:67], v[80:83], v[192:195], v[64:67]
s_mov_b32 s42, 405504
buffer_load_dwordx4 v[200:203], v6, s[44:47], s42 offen nt
s_waitcnt vmcnt(1)
v_mfma_f32_16x16x32_bf16 v[68:71], v[80:83], v[196:199], v[68:71]
buffer_load_dwordx4 v[204:207], v6, s[52:55], s42 offen nt
v_and_b32_dpp v80, v24, v12 row_newbcast:12 row_mask:0xf bank_mask:0xf
v_and_b32_dpp v81, v24, v13 row_newbcast:12 row_mask:0xf bank_mask:0xf
v_and_b32_dpp v82, v24, v14 row_newbcast:12 row_mask:0xf bank_mask:0xf
v_and_b32_dpp v83, v24, v15 row_newbcast:12 row_mask:0xf bank_mask:0xf
s_waitcnt vmcnt(1)
v_mfma_f32_16x16x32_bf16 v[64:67], v[84:87], v[200:203], v[64:67]
s_mov_b32 s42, 442368
buffer_load_dwordx4 v[208:211], v6, s[44:47], s42 offen nt
s_waitcnt vmcnt(1)
v_mfma_f32_16x16x32_bf16 v[68:71], v[84:87], v[204:207], v[68:71]
buffer_load_dwordx4 v[212:215], v6, s[52:55], s42 offen nt
v_and_b32_dpp v84, v24, v12 row_newbcast:13 row_mask:0xf bank_mask:0xf
v_and_b32_dpp v85, v24, v13 row_newbcast:13 row_mask:0xf bank_mask:0xf
v_and_b32_dpp v86, v24, v14 row_newbcast:13 row_mask:0xf bank_mask:0xf
v_and_b32_dpp v87, v24, v15 row_newbcast:13 row_mask:0xf bank_mask:0xf
s_waitcnt vmcnt(1)
v_mfma_f32_16x16x32_bf16 v[64:67], v[80:83], v[208:211], v[64:67]
s_mov_b32 s42, 479232
buffer_load_dwordx4 v[216:219], v6, s[44:47], s42 offen nt
s_waitcnt vmcnt(1)
v_mfma_f32_16x16x32_bf16 v[68:71], v[80:83], v[212:215], v[68:71]
buffer_load_dwordx4 v[220:223], v6, s[52:55], s42 offen nt
v_and_b32_dpp v80, v24, v12 row_newbcast:14 row_mask:0xf bank_mask:0xf
v_and_b32_dpp v81, v24, v13 row_newbcast:14 row_mask:0xf bank_mask:0xf
v_and_b32_dpp v82, v24, v14 row_newbcast:14 row_mask:0xf bank_mask:0xf
v_and_b32_dpp v83, v24, v15 row_newbcast:14 row_mask:0xf bank_mask:0xf
s_waitcnt vmcnt(1)
v_mfma_f32_16x16x32_bf16 v[64:67], v[84:87], v[216:219], v[64:67]
s_mov_b32 s42, 516096
buffer_load_dwordx4 v[224:227], v6, s[44:47], s42 offen nt
s_waitcnt vmcnt(1)
v_mfma_f32_16x16x32_bf16 v[68:71], v[84:87], v[220:223], v[68:71]
buffer_load_dwordx4 v[228:231], v6, s[52:55], s42 offen nt
v_and_b32_dpp v84, v24, v12 row_newbcast:15 row_mask:0xf bank_mask:0xf
v_and_b32_dpp v85, v24, v13 row_newbcast:15 row_mask:0xf bank_mask:0xf
v_and_b32_dpp v86, v24, v14 row_newbcast:15 row_mask:0xf bank_mask:0xf
v_and_b32_dpp v87, v24, v15 row_newbcast:15 row_mask:0xf bank_mask:0xf
s_waitcnt vmcnt(1)
v_mfma_f32_16x16x32_bf16 v[64:67], v[80:83], v[224:227], v[64:67]
s_mov_b32 s42, 552960
buffer_load_dwordx4 v[232:235], v6, s[44:47], s42 offen nt
s_waitcnt vmcnt(1)
v_mfma_f32_16x16x32_bf16 v[68:71], v[80:83], v[228:231], v[68:71]
buffer_load_dwordx4 v[236:239], v6, s[52:55], s42 offen nt
v_and_b32_dpp v80, v25, v12 row_newbcast:0 row_mask:0xf bank_mask:0xf
v_and_b32_dpp v81, v25, v13 row_newbcast:0 row_mask:0xf bank_mask:0xf
v_and_b32_dpp v82, v25, v14 row_newbcast:0 row_mask:0xf bank_mask:0xf
v_and_b32_dpp v83, v25, v15 row_newbcast:0 row_mask:0xf bank_mask:0xf
s_waitcnt vmcnt(1)
v_mfma_f32_16x16x32_bf16 v[64:67], v[84:87], v[232:235], v[64:67]
s_mov_b32 s42, 589824
buffer_load_dwordx4 v[240:243], v6, s[44:47], s42 offen nt
s_waitcnt vmcnt(1)
v_mfma_f32_16x16x32_bf16 v[68:71], v[84:87], v[236:239], v[68:71]
buffer_load_dwordx4 v[244:247], v6, s[52:55], s42 offen nt
v_and_b32_dpp v84, v25, v12 row_newbcast:1 row_mask:0xf bank_mask:0xf
v_and_b32_dpp v85, v25, v13 row_newbcast:1 row_mask:0xf bank_mask:0xf
v_and_b32_dpp v86, v25, v14 row_newbcast:1 row_mask:0xf bank_mask:0xf
v_and_b32_dpp v87, v25, v15 row_newbcast:1 row_mask:0xf bank_mask:0xf
s_waitcnt vmcnt(1)
v_mfma_f32_16x16x32_bf16 v[64:67], v[80:83], v[240:243], v[64:67]
s_mov_b32 s42, 626688
buffer_load_dwordx4 v[248:251], v6, s[44:47], s42 offen nt
s_waitcnt vmcnt(1)
v_mfma_f32_16x16x32_bf16 v[68:71], v[80:83], v[244:247], v[68:71]
buffer_load_dwordx4 v[252:255], v6, s[52:55], s42 offen nt
s_nop 1
s_waitcnt vmcnt(1)
v_mfma_f32_16x16x32_bf16 v[64:67], v[84:87], v[248:251], v[64:67]
s_waitcnt vmcnt(0)
v_mfma_f32_16x16x32_bf16 v[68:71], v[84:87], v[252:255], v[68:71]
s_getreg_b32 s58, hwreg(HW_REG_XCC_ID)
s_and_b32 s58, s58, 7
s_and_b32 s40, s63, 0xf8
s_or_b32 s58, s58, s40
s_lshl_b32 s40, s33, 14
s_add_u32 s40, s40, 1507328
v_and_b32 v3, 31, v0
v_lshl_add_u32 v3, v3, 9, s40
global_load_dwordx4 v[72:75], v3, s[26:27] offset:496 nt
s_mul_i32 s40, s33, 5
s_add_u32 s40, s40, s56
s_lshl_b32 s40, s40, 3
s_add_u32 s40, s40, s30
s_lshl_b32 s40, s40, 10
s_add_u32 s40, s40, 589824
v_lshlrev_b32 v5, 5, v10
v_lshl_add_u32 v5, v11, 4, v5
v_add_u32 v5, s40, v5
v_and_or_b32 v64, v64, s97, v27
v_and_or_b32 v65, v65, s97, v27
v_and_or_b32 v66, v66, s97, v27
v_and_or_b32 v67, v67, s97, v27
v_and_or_b32 v68, v68, s97, v27
v_and_or_b32 v69, v69, s97, v27
v_and_or_b32 v70, v70, s97, v27
v_and_or_b32 v71, v71, s97, v27
s_waitcnt vmcnt(0)
v_xor_b32 v72, s58, v72
v_xor_b32 v73, s58, v73
v_xor_b32 v74, s58, v74
v_xor_b32 v75, s58, v75
v_or3_b32 v4, v72, v73, v74
v_or_b32 v4, v4, v75
v_and_b32 v4, 0xff, v4
v_cmp_ne_u32 vcc, 0, v4
s_cmp_eq_u64 vcc, 0
s_cselect_b32 s59, 1, 0
s_mov_b32 exec_hi, 0
s_cmp_eq_u32 s59, 0
s_cbranch_scc1 L_sw3
global_store_dwordx4 v5, v[64:67], s[26:27]
global_store_dwordx4 v5, v[68:71], s[26:27] offset:512
s_branch L_sd4
L_sw3:
global_store_dwordx4 v5, v[64:67], s[26:27] sc0 sc1
global_store_dwordx4 v5, v[68:71], s[26:27] offset:512 sc0 sc1
L_sd4:
s_mov_b64 exec, -1
s_cmp_eq_u32 s57, 0
s_cbranch_scc1 L_hC
s_sleep 127
s_mul_i32 s40, s34, 18
v_add_u32 v3, s40, v11
s_mul_i32 s40, s33, 40960
s_add_u32 s40, s40, 589824
v_lshl_add_u32 v7, v8, 10, s40
v_add_u32 v4, 0, v3
v_min_u32 v4, 575, v4
v_lshrrev_b32 v5, 7, v4
v_lshl_add_u32 v5, v5, 13, v7
v_and_b32 v4, 127, v4
v_lshl_add_u32 v16, v4, 2, v5
v_add_u32 v4, 4, v3
v_min_u32 v4, 575, v4
v_lshrrev_b32 v5, 7, v4
v_lshl_add_u32 v5, v5, 13, v7
v_and_b32 v4, 127, v4
v_lshl_add_u32 v17, v4, 2, v5
v_add_u32 v4, 8, v3
v_min_u32 v4, 575, v4
v_lshrrev_b32 v5, 7, v4
v_lshl_add_u32 v5, v5, 13, v7
v_and_b32 v4, 127, v4
v_lshl_add_u32 v18, v4, 2, v5
v_add_u32 v4, 12, v3
v_min_u32 v4, 575, v4
v_lshrrev_b32 v5, 7, v4
v_lshl_add_u32 v5, v5, 13, v7
v_and_b32 v4, 127, v4
v_lshl_add_u32 v19, v4, 2, v5
v_add_u32 v4, 16, v3
v_min_u32 v4, 575, v4
v_lshrrev_b32 v5, 7, v4
v_lshl_add_u32 v5, v5, 13, v7
v_and_b32 v4, 127, v4
v_lshl_add_u32 v20, v4, 2, v5
L_gpoll:
s_cmp_eq_u32 s59, 0
s_cbranch_scc1 L_lw5
global_load_dword v28, v16, s[26:27] offset:0 nt
global_load_dword v29, v16, s[26:27] offset:512 nt
global_load_dword v30, v17, s[26:27] offset:0 nt
global_load_dword v31, v17, s[26:27] offset:512 nt
global_load_dword v32, v18, s[26:27] offset:0 nt
global_load_dword v33, v18, s[26:27] offset:512 nt
global_load_dword v34, v19, s[26:27] offset:0 nt
global_load_dword v35, v19, s[26:27] offset:512 nt
global_load_dword v36, v20, s[26:27] offset:0 nt
global_load_dword v37, v20, s[26:27] offset:512 nt
s_branch L_ld6
L_lw5:
global_load_dword v28, v16, s[26:27] offset:0 sc1
global_load_dword v29, v16, s[26:27] offset:512 sc1
global_load_dword v30, v17, s[26:27] offset:0 sc1
global_load_dword v31, v17, s[26:27] offset:512 sc1
global_load_dword v32, v18, s[26:27] offset:0 sc1
global_load_dword v33, v18, s[26:27] offset:512 sc1
global_load_dword v34, v19, s[26:27] offset:0 sc1
global_load_dword v35, v19, s[26:27] offset:512 sc1
global_load_dword v36, v20, s[26:27] offset:0 sc1
global_load_dword v37, v20, s[26:27] offset:512 sc1
L_ld6:
s_waitcnt vmcnt(0)
v_xor_b32 v28, s96, v28
v_xor_b32 v29, s96, v29
v_xor_b32 v30, s96, v30
v_xor_b32 v31, s96, v31
v_xor_b32 v32, s96, v32
v_xor_b32 v33, s96, v33
v_xor_b32 v34, s96, v34
v_xor_b32 v35, s96, v35
v_xor_b32 v36, s96, v36
v_xor_b32 v37, s96, v37
v_or3_b32 v3, v28, v29, v30
v_or3_b32 v3, v3, v31, v32
v_or3_b32 v3, v3, v33, v34
v_or3_b32 v3, v3, v35, v36
v_or_b32 v3, v3, v37
v_and_b32 v3, 0xff, v3
v_cmp_ne_u32 vcc, 0, v3
s_cbranch_vccz L_gdone
s_sleep 64
s_sub_u32 s94, s94, 1
s_cbranch_scc0 L_gpoll
L_gdone:
v_add_f32_dpp v28, v28, v28 quad_perm:[1,0,3,2] row_mask:0xf bank_mask:0xf
v_add_f32_dpp v29, v29, v29 quad_perm:[1,0,3,2] row_mask:0xf bank_mask:0xf
v_add_f32_dpp v30, v30, v30 quad_perm:[1,0,3,2] row_mask:0xf bank_mask:0xf
v_add_f32_dpp v31, v31, v31 quad_perm:[1,0,3,2] row_mask:0xf bank_mask:0xf
v_add_f32_dpp v32, v32, v32 quad_perm:[1,0,3,2] row_mask:0xf bank_mask:0xf
v_add_f32_dpp v33, v33, v33 quad_perm:[1,0,3,2] row_mask:0xf bank_mask:0xf
v_add_f32_dpp v34, v34, v34 quad_perm:[1,0,3,2] row_mask:0xf bank_mask:0xf
v_add_f32_dpp v35, v35, v35 quad_perm:[1,0,3,2] row_mask:0xf bank_mask:0xf
v_add_f32_dpp v36, v36, v36 quad_perm:[1,0,3,2] row_mask:0xf bank_mask:0xf
v_add_f32_dpp v37, v37, v37 quad_perm:[1,0,3,2] row_mask:0xf bank_mask:0xf
v_add_f32_dpp v28, v28, v28 quad_perm:[2,3,0,1] row_mask:0xf bank_mask:0xf
v_add_f32_dpp v29, v29, v29 quad_perm:[2,3,0,1] row_mask:0xf bank_mask:0xf
v_add_f32_dpp v30, v30, v30 quad_perm:[2,3,0,1] row_mask:0xf bank_mask:0xf
v_add_f32_dpp v31, v31, v31 quad_perm:[2,3,0,1] row_mask:0xf bank_mask:0xf
v_add_f32_dpp v32, v32, v32 quad_perm:[2,3,0,1] row_mask:0xf bank_mask:0xf
v_add_f32_dpp v33, v33, v33 quad_perm:[2,3,0,1] row_mask:0xf bank_mask:0xf
v_add_f32_dpp v34, v34, v34 quad_perm:[2,3,0,1] row_mask:0xf bank_mask:0xf
v_add_f32_dpp v35, v35, v35 quad_perm:[2,3,0,1] row_mask:0xf bank_mask:0xf
v_add_f32_dpp v36, v36, v36 quad_perm:[2,3,0,1] row_mask:0xf bank_mask:0xf
v_add_f32_dpp v37, v37, v37 quad_perm:[2,3,0,1] row_mask:0xf bank_mask:0xf
v_add_f32_dpp v28, v28, v28 row_half_mirror row_mask:0xf bank_mask:0xf
v_add_f32_dpp v29, v29, v29 row_half_mirror row_mask:0xf bank_mask:0xf
v_add_f32_dpp v30, v30, v30 row_half_mirror row_mask:0xf bank_mask:0xf
v_add_f32_dpp v31, v31, v31 row_half_mirror row_mask:0xf bank_mask:0xf
v_add_f32_dpp v32, v32, v32 row_half_mirror row_mask:0xf bank_mask:0xf
v_add_f32_dpp v33, v33, v33 row_half_mirror row_mask:0xf bank_mask:0xf
v_add_f32_dpp v34, v34, v34 row_half_mirror row_mask:0xf bank_mask:0xf
v_add_f32_dpp v35, v35, v35 row_half_mirror row_mask:0xf bank_mask:0xf
v_add_f32_dpp v36, v36, v36 row_half_mirror row_mask:0xf bank_mask:0xf
v_add_f32_dpp v37, v37, v37 row_half_mirror row_mask:0xf bank_mask:0xf
v_cvt_pk_bf16_f32 v28, v28, v29
v_and_b32 v29, 0xffff0000, v28
v_lshlrev_b32 v28, 16, v28
v_mul_f32 v28, v28, v29
v_cvt_pk_bf16_f32 v28, v28, v28
v_cvt_pk_bf16_f32 v30, v30, v31
v_and_b32 v31, 0xffff0000, v30
v_lshlrev_b32 v30, 16, v30
v_mul_f32 v30, v30, v31
v_cvt_pk_bf16_f32 v30, v30, v30
v_cvt_pk_bf16_f32 v32, v32, v33
v_and_b32 v33, 0xffff0000, v32
v_lshlrev_b32 v32, 16, v32
v_mul_f32 v32, v32, v33
v_cvt_pk_bf16_f32 v32, v32, v32
v_cvt_pk_bf16_f32 v34, v34, v35
v_and_b32 v35, 0xffff0000, v34
v_lshlrev_b32 v34, 16, v34
v_mul_f32 v34, v34, v35
v_cvt_pk_bf16_f32 v34, v34, v34
v_cvt_pk_bf16_f32 v36, v36, v37
v_and_b32 v37, 0xffff0000, v36
v_lshlrev_b32 v36, 16, v36
v_mul_f32 v36, v36, v37
v_cvt_pk_bf16_f32 v36, v36, v36
s_mov_b32 exec_lo, 0
v_mov_b32 v36, 0
s_mov_b64 exec, -1
v_mul_u32_u24 v3, 40, v11
s_mov_b32 exec_lo, 0x00010001
s_mov_b32 exec_hi, 0x00010001
v_mov_b32 v29, s63
ds_write_b64 v3, v[28:29] offset:704
v_mov_b32 v31, s63
ds_write_b64 v3, v[30:31] offset:712
v_mov_b32 v33, s63
ds_write_b64 v3, v[32:33] offset:720
v_mov_b32 v35, s63
ds_write_b64 v3, v[34:35] offset:728
v_mov_b32 v37, s63
ds_write_b64 v3, v[36:37] offset:736
s_mov_b64 exec, -1
s_waitcnt lgkmcnt(0)
s_branch L_hC
L_h3:
v_and_b32 v3, 1, v10
v_lshlrev_b32 v3, 4, v3
v_mov_b32 v4, 0xffff
v_lshlrev_b32 v4, v3, v4
v_bfe_u32 v3, v10, 1, 2
v_cmp_eq_u32 vcc, 0, v3
s_nop 1
v_cndmask_b32 v12, 0, v4, vcc
v_cmp_eq_u32 vcc, 1, v3
s_nop 1
v_cndmask_b32 v13, 0, v4, vcc
v_cmp_eq_u32 vcc, 2, v3
s_nop 1
v_cndmask_b32 v14, 0, v4, vcc
v_cmp_eq_u32 vcc, 3, v3
s_nop 1
v_cndmask_b32 v15, 0, v4, vcc
s_waitcnt lgkmcnt(0)
s_add_u32 s63, s63, 9
s_and_b32 s43, s63, 0x3ff
s_mov_b32 s51, 0xfffffc00
s_and_b32 s96, s63, 0xff
s_mov_b32 s97, 0xffffff00
v_mov_b32 v27, s43
s_not_b32 s40, s63
v_mov_b32 v3, s40
v_lshlrev_b32 v4, 2, v10
ds_write_b32 v4, v3 offset:512
v_lshlrev_b32 v4, 2, v8
ds_write_b32 v4, v3 offset:576
v_lshlrev_b32 v4, 2, v0
ds_write_b32 v4, v3 offset:704
s_waitcnt lgkmcnt(0)
s_barrier
s_lshl_b32 s40, s29, 12
s_lshl_b32 s41, s30, 6
s_add_u32 s40, s40, s41
s_add_u32 s40, s40, 917504
v_lshlrev_b32 v7, 9, v8
v_lshl_add_u32 v7, v11, 4, v7
v_add_u32 v7, s40, v7
v_and_b32 v4, 1, v11
v_lshlrev_b32 v4, 4, v4
v_lshl_add_u32 v4, v10, 5, v4
s_lshl_b32 s40, s31, 9
s_add_u32 s40, s40, 917504
v_add_u32 v6, s40, v4
v_mov_b32 v75, v4
v_mov_b32 v3, 0
ds_read_b32 v3, v3 offset:608
s_waitcnt lgkmcnt(0)
v_readfirstlane_b32 s59, v3
v_lshlrev_b32 v5, 5, v10
v_lshl_add_u32 v5, v11, 4, v5
s_mul_i32 s40, s31, 2304
s_lshl_b32 s41, s35, 9
s_add_u32 s40, s40, s41
v_add_u32 v5, s40, v5
v_mov_b32 v9, 0
v_mov_b32 v27, s43
v_and_b32 v73, 31, v0
s_lshl_b32 s40, s28, 5
v_add_u32 v73, s40, v73
v_lshrrev_b32 v74, 5, v0
v_mul_u32_u24 v68, 2304, v73
v_lshl_add_u32 v68, v74, 4, v68
s_min_u32 s41, s2, 71
s_lshl_b32 s40, s41, 5
v_add_u32 v68, s40, v68
s_lshl_b32 s40, s41, 4
v_lshl_add_u32 v69, v0, 1, s40
v_lshlrev_b32 v70, 2, v0
s_lshl_b32 s40, s28, 5
v_lshl_add_u32 v71, v74, 4, s40
s_mov_b32 s36, s4
s_mov_b32 s37, s5
s_mov_b32 s38, 1152
s_mov_b32 s39, 0x20000
s_mov_b32 s84, s22
s_mov_b32 s85, s23
s_mov_b32 s86, 1152
s_mov_b32 s87, 0x20000
buffer_load_ushort v72, v69, s[36:39], 0 offen
s_mov_b32 s98, -1
s_mov_b32 s99, -1
s_waitcnt vmcnt(0)
L_m4:
s_sleep 16
ds_read_b128 v[28:31], v9 offset:512
ds_read_b128 v[32:35], v9 offset:528
ds_read_b128 v[36:39], v9 offset:544
ds_read_b128 v[40:43], v9 offset:560
s_waitcnt lgkmcnt(0)
v_xor_b32 v29, s63, v29
v_xor_b32 v31, s63, v31
v_xor_b32 v33, s63, v33
v_xor_b32 v35, s63, v35
v_xor_b32 v37, s63, v37
v_xor_b32 v39, s63, v39
v_xor_b32 v41, s63, v41
v_xor_b32 v43, s63, v43
v_or3_b32 v3, v29, v31, v33
v_or3_b32 v3, v3, v35, v37
v_or3_b32 v3, v3, v39, v41
v_or_b32 v3, v3, v43
v_cmp_ne_u32 vcc, 0, v3
s_cbranch_vccz L_m4d
s_sub_u32 s94, s94, 1
s_cbranch_scc0 L_m4
L_m4d:
v_max3_f32 v16, v28, v32, v36
v_max_f32 v16, v16, v40
v_sub_f32 v20, v28, v16
v_sub_f32 v21, v32, v16
v_sub_f32 v22, v36, v16
v_sub_f32 v23, v40, v16
v_exp_f32 v20, v20
v_exp_f32 v21, v21
v_exp_f32 v22, v22
v_exp_f32 v23, v23
v_mov_b32 v17, s63
v_mov_b32 v19, s63
v_mul_f32 v18, v30, v20
v_fmac_f32 v18, v34, v21
v_fmac_f32 v18, v38, v22
v_fmac_f32 v18, v42, v23
s_lshl_b32 s40, s31, 7
s_add_u32 s40, s40, 1441792
v_add_u32 v3, s40, v1
s_mov_b64 exec, 0xff
s_cmp_eq_u32 s59, 0
s_cbranch_scc1 L_sw7
global_store_dwordx4 v3, v[16:19], s[26:27]
s_branch L_sd8
L_sw7:
global_store_dwordx4 v3, v[16:19], s[26:27] sc0 sc1
L_sd8:
s_mov_b64 exec, -1
s_lshl_b32 s40, s29, 10
s_add_u32 s40, s40, 1441792
v_lshl_add_u32 v4, v8, 7, s40
L_mlp:
s_sleep 32
s_cmp_eq_u32 s59, 0
s_cbranch_scc1 L_lw9
global_load_dwordx4 v[28:31], v4, s[26:27] nt
s_branch L_ld10
L_lw9:
global_load_dwordx4 v[28:31], v4, s[26:27] sc1
L_ld10:
s_waitcnt vmcnt(0)
v_xor_b32 v29, s63, v29
v_xor_b32 v31, s63, v31
v_or_b32 v3, v29, v31
v_cmp_ne_u32 vcc, 0, v3
s_cbranch_vccz L_mld
s_sub_u32 s94, s94, 1
s_cbranch_scc0 L_mlp
L_mld:
v_mov_b32 v24, v28
s_nop 1
v_max_f32_dpp v24, v24, v24 quad_perm:[1,0,3,2] row_mask:0xf bank_mask:0xf
s_nop 1
v_max_f32_dpp v24, v24, v24 quad_perm:[2,3,0,1] row_mask:0xf bank_mask:0xf
s_nop 1
v_max_f32_dpp v24, v24, v24 row_half_mirror row_mask:0xf bank_mask:0xf
v_sub_f32 v25, v28, v24
v_exp_f32 v25, v25
s_nop 0
v_mul_f32 v25, v30, v25
s_nop 1
v_add_f32_dpp v25, v25, v25 quad_perm:[1,0,3,2] row_mask:0xf bank_mask:0xf
s_nop 1
v_add_f32_dpp v25, v25, v25 quad_perm:[2,3,0,1] row_mask:0xf bank_mask:0xf
s_nop 1
v_add_f32_dpp v25, v25, v25 row_half_mirror row_mask:0xf bank_mask:0xf
v_rcp_f32 v25, v25
v_sub_f32 v24, v16, v24
v_exp_f32 v24, v24
s_nop 0
v_mul_f32 v24, v24, v25
v_mul_f32 v28, v20, v24
v_mov_b32 v29, s63
v_mul_f32 v30, v21, v24
v_mov_b32 v31, s63
v_mul_f32 v32, v22, v24
v_mov_b32 v33, s63
v_mul_f32 v34, v23, v24
v_mov_b32 v35, s63
ds_write_b128 v9, v[28:31] offset:576
ds_write_b128 v9, v[32:35] offset:592
s_waitcnt lgkmcnt(0)
v_mul_u32_u24 v3, 40, v11
L_hb11:
s_sleep 8
ds_read_b64 v[28:29], v3 offset:704
ds_read_b64 v[30:31], v3 offset:712
ds_read_b64 v[32:33], v3 offset:720
ds_read_b64 v[34:35], v3 offset:728
ds_read_b64 v[36:37], v3 offset:736
s_waitcnt lgkmcnt(0)
v_xor_b32 v29, s63, v29
v_xor_b32 v31, s63, v31
v_xor_b32 v33, s63, v33
v_xor_b32 v35, s63, v35
v_xor_b32 v37, s63, v37
v_or3_b32 v4, v29, v31, v33
v_or3_b32 v4, v4, v35, v37
v_cmp_ne_u32 vcc, 0, v4
s_cbranch_vccz L_hb11d
s_sub_u32 s94, s94, 1
s_cbranch_scc0 L_hb11
L_hb11d:
v_and_b32 v192, v28, v12
v_and_b32 v193, v28, v13
v_and_b32 v194, v28, v14
v_and_b32 v195, v28, v15
v_and_b32 v196, v30, v12
v_and_b32 v197, v30, v13
v_and_b32 v198, v30, v14
v_and_b32 v199, v30, v15
v_and_b32 v200, v32, v12
v_and_b32 v201, v32, v13
v_and_b32 v202, v32, v14
v_and_b32 v203, v32, v15
v_and_b32 v204, v34, v12
v_and_b32 v205, v34, v13
v_and_b32 v206, v34, v14
v_and_b32 v207, v34, v15
v_and_b32 v208, v36, v12
v_and_b32 v209, v36, v13
v_and_b32 v210, v36, v14
v_and_b32 v211, v36, v15
s_mul_i32 s40, s31, 18432
s_add_u32 s44, s12, s40
s_addc_u32 s45, s13, 0
s_mov_b32 s46, 18432
s_mov_b32 s47, 0x20000
s_mul_i32 s40, s31, 20736
s_add_u32 s88, s20, s40
s_addc_u32 s89, s21, 0
s_mov_b32 s90, 20736
s_mov_b32 s91, 0x20000
s_lshl_b32 s40, s35, 8
v_lshl_add_u32 v28, v10, 4, s40
v_lshlrev_b32 v29, 4, v8
v_add_u32 v29, 0x400, v29
v_mul_u32_u24 v4, 4608, v11
v_add_u32 v30, v4, v28
v_add_u32 v31, v4, v29
v_mul_u32_u24 v4, 1152, v11
v_add_u32 v28, v4, v28
v_add_u32 v29, v4, v29
s_mov_b32 s48, 4608
s_mov_b32 s49, 9216
s_mov_b32 s50, 13824
s_mov_b32 s62, 18432
L_tr12:
ds_read_b32 v3, v9 offset:656
s_waitcnt lgkmcnt(0)
v_readfirstlane_b32 s40, v3
s_cmp_eq_u32 s40, 100
s_cbranch_scc1 L_tr12d
s_sleep 2
s_sub_u32 s94, s94, 1
s_cbranch_scc0 L_tr12
L_tr12d:
buffer_load_dwordx4 v[212:215], v30, s[44:47], 0 offen offset:0 nt
buffer_load_dwordx4 v[216:219], v30, s[44:47], 0 offen offset:1152 nt
buffer_load_dwordx4 v[220:223], v30, s[44:47], 0 offen offset:2304 nt
buffer_load_dwordx4 v[224:227], v30, s[44:47], 0 offen offset:3456 nt
buffer_load_dwordx4 v[228:231], v31, s[44:47], 0 offen offset:0 nt
buffer_load_dwordx4 v[232:235], v31, s[44:47], 0 offen offset:1152 nt
buffer_load_dwordx4 v[236:239], v31, s[44:47], 0 offen offset:2304 nt
buffer_load_dwordx4 v[240:243], v31, s[44:47], 0 offen offset:3456 nt
buffer_load_dwordx4 v[112:115], v28, s[88:91], 0 offen nt
buffer_load_dwordx4 v[116:119], v28, s[88:91], s48 offen nt
buffer_load_dwordx4 v[120:123], v28, s[88:91], s49 offen nt
buffer_load_dwordx4 v[124:127], v28, s[88:91], s50 offen nt
buffer_load_dwordx4 v[128:131], v28, s[88:91], s62 offen nt
buffer_load_dwordx4 v[132:135], v29, s[88:91], 0 offen nt
buffer_load_dwordx4 v[136:139], v29, s[88:91], s48 offen nt
buffer_load_dwordx4 v[140:143], v29, s[88:91], s49 offen nt
buffer_load_dwordx4 v[144:147], v29, s[88:91], s50 offen nt
buffer_load_dwordx4 v[148:151], v29, s[88:91], s62 offen nt
s_barrier
L_tail:
s_cmp_eq_u32 s35, 3
s_cbranch_scc0 L_nom
ds_read_b128 v[52:55], v75 offset:6144
ds_read_b128 v[56:59], v75 offset:6656
ds_read_b128 v[60:63], v75 offset:7168
ds_read_b128 v[64:67], v75 offset:7680
s_waitcnt lgkmcnt(2)
v_add_f32 v52, v52, v56
v_add_f32 v53, v53, v57
v_add_f32 v54, v54, v58
v_add_f32 v55, v55, v59
s_waitcnt lgkmcnt(0)
v_add_f32 v60, v60, v64
v_add_f32 v61, v61, v65
v_add_f32 v62, v62, v66
v_add_f32 v63, v63, v67
v_add_f32 v52, v52, v60
v_add_f32 v53, v53, v61
v_add_f32 v54, v54, v62
v_add_f32 v55, v55, v63
v_and_or_b32 v52, v52, s51, v27
v_and_or_b32 v53, v53, s51, v27
v_and_or_b32 v54, v54, s51, v27
v_and_or_b32 v55, v55, s51, v27
s_mov_b32 exec_hi, 0
s_cmp_eq_u32 s59, 0
s_cbranch_scc1 L_sw13
global_store_dwordx4 v6, v[52:55], s[26:27]
s_branch L_sd14
L_sw13:
global_store_dwordx4 v6, v[52:55], s[26:27] sc0 sc1
L_sd14:
s_mov_b64 exec, s[98:99]
L_nom:
s_sleep 3
s_mov_b32 s42, 1
L_oxc:
s_cmp_eq_u32 s59, 0
s_cbranch_scc1 L_lw15
global_load_dwordx4 v[32:35], v7, s[26:27] nt
s_branch L_ld16
L_lw15:
global_load_dwordx4 v[32:35], v7, s[26:27] sc1
L_ld16:
s_waitcnt vmcnt(0)
s_cmp_eq_u32 s42, 0
s_cbranch_scc1 L_nowd
s_mov_b32 s42, 0
v_mfma_f32_16x16x32_bf16 v[44:47], v[192:195], v[112:115], 0
v_mfma_f32_16x16x32_bf16 v[44:47], v[196:199], v[116:119], v[44:47]
v_mfma_f32_16x16x32_bf16 v[44:47], v[200:203], v[120:123], v[44:47]
v_mfma_f32_16x16x32_bf16 v[44:47], v[204:207], v[124:127], v[44:47]
v_mfma_f32_16x16x32_bf16 v[44:47], v[208:211], v[128:131], v[44:47]
s_cmp_eq_u32 s35, 3
s_cbranch_scc0 L_nowd
v_mfma_f32_16x16x32_bf16 v[48:51], v[192:195], v[132:135], 0
v_mfma_f32_16x16x32_bf16 v[48:51], v[196:199], v[136:139], v[48:51]
v_mfma_f32_16x16x32_bf16 v[48:51], v[200:203], v[140:143], v[48:51]
v_mfma_f32_16x16x32_bf16 v[48:51], v[204:207], v[144:147], v[48:51]
v_mfma_f32_16x16x32_bf16 v[48:51], v[208:211], v[148:151], v[48:51]
L_nowd:
v_xor_b32 v32, s43, v32
v_xor_b32 v33, s43, v33
v_xor_b32 v34, s43, v34
v_xor_b32 v35, s43, v35
v_or3_b32 v26, v32, v33, v34
v_or_b32 v26, v26, v35
v_and_b32 v26, 0x3ff, v26
v_cmp_ne_u32 vcc, 0, v26
s_and_b64 exec, exec, vcc
s_cbranch_execz L_oxd
s_sleep 1
s_sub_u32 s94, s94, 1
s_cbranch_scc0 L_oxc
L_oxd:
s_mov_b64 exec, s[98:99]
s_nop 0
v_add_f32_dpp v32, v32, v32 quad_perm:[1,0,3,2] row_mask:0xf bank_mask:0xf
v_add_f32_dpp v33, v33, v33 quad_perm:[1,0,3,2] row_mask:0xf bank_mask:0xf
v_add_f32_dpp v34, v34, v34 quad_perm:[1,0,3,2] row_mask:0xf bank_mask:0xf
v_add_f32_dpp v35, v35, v35 quad_perm:[1,0,3,2] row_mask:0xf bank_mask:0xf
v_add_f32_dpp v32, v32, v32 quad_perm:[2,3,0,1] row_mask:0xf bank_mask:0xf
v_add_f32_dpp v33, v33, v33 quad_perm:[2,3,0,1] row_mask:0xf bank_mask:0xf
v_add_f32_dpp v34, v34, v34 quad_perm:[2,3,0,1] row_mask:0xf bank_mask:0xf
v_add_f32_dpp v35, v35, v35 quad_perm:[2,3,0,1] row_mask:0xf bank_mask:0xf
v_add_f32_dpp v32, v32, v32 row_half_mirror row_mask:0xf bank_mask:0xf
v_add_f32_dpp v33, v33, v33 row_half_mirror row_mask:0xf bank_mask:0xf
v_add_f32_dpp v34, v34, v34 row_half_mirror row_mask:0xf bank_mask:0xf
v_add_f32_dpp v35, v35, v35 row_half_mirror row_mask:0xf bank_mask:0xf
v_cvt_pk_bf16_f32 v32, v32, v32
v_cvt_pk_bf16_f32 v33, v33, v33
v_cvt_pk_bf16_f32 v34, v34, v34
v_cvt_pk_bf16_f32 v35, v35, v35
v_and_b32 v80, v32, v12
v_and_b32 v81, v32, v13
v_and_b32 v82, v32, v14
v_and_b32 v83, v32, v15
v_and_b32 v84, v33, v12
v_and_b32 v85, v33, v13
v_and_b32 v86, v33, v14
v_and_b32 v87, v33, v15
v_and_b32 v88, v34, v12
v_and_b32 v89, v34, v13
v_and_b32 v90, v34, v14
v_and_b32 v91, v34, v15
v_and_b32 v92, v35, v12
v_and_b32 v93, v35, v13
v_and_b32 v94, v35, v14
v_and_b32 v95, v35, v15
s_nop 0
v_mfma_f32_16x16x32_bf16 v[44:47], v[80:83], v[212:215], v[44:47]
v_mfma_f32_16x16x32_bf16 v[44:47], v[84:87], v[216:219], v[44:47]
v_mfma_f32_16x16x32_bf16 v[44:47], v[88:91], v[220:223], v[44:47]
v_mfma_f32_16x16x32_bf16 v[44:47], v[92:95], v[224:227], v[44:47]
s_cmp_eq_u32 s35, 3
s_cbranch_scc0 L_y1
v_mfma_f32_16x16x32_bf16 v[48:51], v[80:83], v[228:231], v[48:51]
v_mfma_f32_16x16x32_bf16 v[48:51], v[84:87], v[232:235], v[48:51]
v_mfma_f32_16x16x32_bf16 v[48:51], v[88:91], v[236:239], v[48:51]
v_mfma_f32_16x16x32_bf16 v[48:51], v[92:95], v[240:243], v[48:51]
L_y1:
s_mov_b32 exec_hi, 0
s_nop 4
v_and_or_b32 v44, v44, s51, v27
v_and_or_b32 v45, v45, s51, v27
v_and_or_b32 v46, v46, s51, v27
v_and_or_b32 v47, v47, s51, v27
global_store_dwordx4 v5, v[44:47], s[26:27] sc0 sc1
s_cbranch_scc0 L_y3
s_and_b32 exec_lo, s98, 0x00ff00ff
v_and_or_b32 v48, v48, s51, v27
v_and_or_b32 v49, v49, s51, v27
v_and_or_b32 v50, v50, s51, v27
v_and_or_b32 v51, v51, s51, v27
global_store_dwordx4 v5, v[48:51], s[26:27] offset:512 sc0 sc1
L_y3:
s_mov_b64 exec, s[98:99]
L_final:
s_cmp_ge_u32 s2, 72
s_cbranch_scc1 L_fin0
s_cmp_eq_u32 s98, 0
s_cbranch_scc1 L_pa
s_barrier
L_pa:
L_pa1:
global_load_dwordx4 v[76:79], v68, s[26:27] sc0 sc1
s_waitcnt vmcnt(0)
v_xor_b32 v76, s43, v76
v_xor_b32 v77, s43, v77
v_xor_b32 v78, s43, v78
v_xor_b32 v79, s43, v79
v_or3_b32 v73, v76, v77, v78
v_or_b32 v73, v73, v79
v_and_b32 v73, 0x3ff, v73
v_cmp_ne_u32 vcc, 0, v73
s_and_b64 exec, exec, vcc
s_cbranch_execz L_da
s_sub_u32 s94, s94, 1
s_cbranch_scc0 L_pa1
L_da:
s_mov_b64 exec, s[98:99]
v_add_f32_dpp v76, v76, v76 row_ror:1 row_mask:0xf bank_mask:0xf
v_add_f32_dpp v77, v77, v77 row_ror:1 row_mask:0xf bank_mask:0xf
v_add_f32_dpp v78, v78, v78 row_ror:1 row_mask:0xf bank_mask:0xf
v_add_f32_dpp v79, v79, v79 row_ror:1 row_mask:0xf bank_mask:0xf
v_add_f32_dpp v76, v76, v76 row_ror:2 row_mask:0xf bank_mask:0xf
v_add_f32_dpp v77, v77, v77 row_ror:2 row_mask:0xf bank_mask:0xf
v_add_f32_dpp v78, v78, v78 row_ror:2 row_mask:0xf bank_mask:0xf
v_add_f32_dpp v79, v79, v79 row_ror:2 row_mask:0xf bank_mask:0xf
v_add_f32_dpp v76, v76, v76 row_ror:4 row_mask:0xf bank_mask:0xf
v_add_f32_dpp v77, v77, v77 row_ror:4 row_mask:0xf bank_mask:0xf
v_add_f32_dpp v78, v78, v78 row_ror:4 row_mask:0xf bank_mask:0xf
v_add_f32_dpp v79, v79, v79 row_ror:4 row_mask:0xf bank_mask:0xf
v_add_f32_dpp v76, v76, v76 row_ror:8 row_mask:0xf bank_mask:0xf
v_add_f32_dpp v77, v77, v77 row_ror:8 row_mask:0xf bank_mask:0xf
v_add_f32_dpp v78, v78, v78 row_ror:8 row_mask:0xf bank_mask:0xf
v_add_f32_dpp v79, v79, v79 row_ror:8 row_mask:0xf bank_mask:0xf
v_add_f32_dpp v76, v76, v76 row_bcast:15 row_mask:0xa bank_mask:0xf
v_add_f32_dpp v77, v77, v77 row_bcast:15 row_mask:0xa bank_mask:0xf
v_add_f32_dpp v78, v78, v78 row_bcast:15 row_mask:0xa bank_mask:0xf
v_add_f32_dpp v79, v79, v79 row_bcast:15 row_mask:0xa bank_mask:0xf
s_and_b32 exec_lo, s98, 0x80000000
s_and_b32 exec_hi, s98, 0x80000000
ds_write_b128 v71, v[76:79] offset:256
s_waitcnt lgkmcnt(0)
s_cmp_eq_u32 s98, 0
s_cbranch_scc1 L_out
s_barrier
s_cmp_lg_u32 s28, 0
s_cbranch_scc1 L_ep
L_out:
s_and_b32 exec_lo, s98, 0xff
s_and_b32 exec_hi, s98, 0
ds_read2_b32 v[32:33], v70 offset0:64 offset1:72
ds_read2_b32 v[34:35], v70 offset0:80 offset1:88
ds_read2_b32 v[36:37], v70 offset0:96 offset1:104
ds_read2_b32 v[38:39], v70 offset0:112 offset1:120
v_lshlrev_b32 v72, 16, v72
s_waitcnt lgkmcnt(0)
v_add_f32 v32, v32, v36
v_add_f32 v33, v33, v37
v_add_f32 v34, v34, v38
v_add_f32 v35, v35, v39
v_add_f32 v32, v32, v34
v_add_f32 v33, v33, v35
v_add_f32 v32, v32, v33
v_add_f32 v32, v72, v32
v_cvt_pk_bf16_f32 v32, v32, v32
buffer_store_short v32, v69, s[84:87], 0 offen
L_fin0:
s_branch L_fin
L_ep:
s_cmp_lg_u32 s2, 0
s_cbranch_scc1 L_fin
s_cmp_lg_u32 s28, 4
s_cbranch_scc1 L_fin
s_mov_b64 exec, 1
v_mov_b32 v3, 0x190004
v_mov_b32 v4, s63
global_store_dword v3, v4, s[26:27] sc0 sc1
L_fin:
L_end:
s_endpgm
L_hC:
s_lshl_b32 s40, s29, 12
s_lshl_b32 s41, s30, 6
s_add_u32 s40, s40, s41
s_add_u32 s40, s40, 917504
v_lshlrev_b32 v7, 9, v8
v_lshl_add_u32 v7, v11, 4, v7
v_add_u32 v7, s40, v7
v_and_b32 v4, 1, v11
v_lshlrev_b32 v4, 4, v4
v_lshl_add_u32 v4, v10, 5, v4
s_lshl_b32 s40, s31, 9
s_add_u32 s40, s40, 917504
v_add_u32 v6, s40, v4
v_mov_b32 v75, v4
v_mov_b32 v3, 0
ds_read_b32 v3, v3 offset:608
s_waitcnt lgkmcnt(0)
v_readfirstlane_b32 s59, v3
v_lshlrev_b32 v5, 5, v10
v_lshl_add_u32 v5, v11, 4, v5
s_mul_i32 s40, s31, 2304
s_lshl_b32 s41, s35, 9
s_add_u32 s40, s40, s41
v_add_u32 v5, s40, v5
v_mov_b32 v9, 0
v_mov_b32 v27, s43
v_and_b32 v73, 31, v0
s_lshl_b32 s40, s28, 5
v_add_u32 v73, s40, v73
v_lshrrev_b32 v74, 5, v0
v_mul_u32_u24 v68, 2304, v73
v_lshl_add_u32 v68, v74, 4, v68
s_min_u32 s41, s2, 71
s_lshl_b32 s40, s41, 5
v_add_u32 v68, s40, v68
s_lshl_b32 s40, s41, 4
v_lshl_add_u32 v69, v0, 1, s40
v_lshlrev_b32 v70, 2, v0
s_lshl_b32 s40, s28, 5
v_lshl_add_u32 v71, v74, 4, s40
s_mov_b32 s36, s4
s_mov_b32 s37, s5
s_mov_b32 s38, 1152
s_mov_b32 s39, 0x20000
s_mov_b32 s84, s22
s_mov_b32 s85, s23
s_mov_b32 s86, 1152
s_mov_b32 s87, 0x20000
buffer_load_ushort v72, v69, s[36:39], 0 offen
s_mov_b32 s98, -1
s_mov_b32 s99, -1
s_waitcnt vmcnt(0)
v_mul_u32_u24 v3, 40, v11
L_hb17:
s_sleep 8
ds_read_b64 v[28:29], v3 offset:704
ds_read_b64 v[30:31], v3 offset:712
ds_read_b64 v[32:33], v3 offset:720
ds_read_b64 v[34:35], v3 offset:728
ds_read_b64 v[36:37], v3 offset:736
s_waitcnt lgkmcnt(0)
v_xor_b32 v29, s63, v29
v_xor_b32 v31, s63, v31
v_xor_b32 v33, s63, v33
v_xor_b32 v35, s63, v35
v_xor_b32 v37, s63, v37
v_or3_b32 v4, v29, v31, v33
v_or3_b32 v4, v4, v35, v37
v_cmp_ne_u32 vcc, 0, v4
s_cbranch_vccz L_hb17d
s_sub_u32 s94, s94, 1
s_cbranch_scc0 L_hb17
L_hb17d:
v_and_b32 v192, v28, v12
v_and_b32 v193, v28, v13
v_and_b32 v194, v28, v14
v_and_b32 v195, v28, v15
v_and_b32 v196, v30, v12
v_and_b32 v197, v30, v13
v_and_b32 v198, v30, v14
v_and_b32 v199, v30, v15
v_and_b32 v200, v32, v12
v_and_b32 v201, v32, v13
v_and_b32 v202, v32, v14
v_and_b32 v203, v32, v15
v_and_b32 v204, v34, v12
v_and_b32 v205, v34, v13
v_and_b32 v206, v34, v14
v_and_b32 v207, v34, v15
v_and_b32 v208, v36, v12
v_and_b32 v209, v36, v13
v_and_b32 v210, v36, v14
v_and_b32 v211, v36, v15
s_mul_i32 s40, s31, 18432
s_add_u32 s44, s12, s40
s_addc_u32 s45, s13, 0
s_mov_b32 s46, 18432
s_mov_b32 s47, 0x20000
s_mul_i32 s40, s31, 20736
s_add_u32 s88, s20, s40
s_addc_u32 s89, s21, 0
s_mov_b32 s90, 20736
s_mov_b32 s91, 0x20000
s_lshl_b32 s40, s35, 8
v_lshl_add_u32 v28, v10, 4, s40
v_lshlrev_b32 v29, 4, v8
v_add_u32 v29, 0x400, v29
v_mul_u32_u24 v4, 4608, v11
v_add_u32 v30, v4, v28
v_add_u32 v31, v4, v29
v_mul_u32_u24 v4, 1152, v11
v_add_u32 v28, v4, v28
v_add_u32 v29, v4, v29
s_mov_b32 s48, 4608
s_mov_b32 s49, 9216
s_mov_b32 s50, 13824
s_mov_b32 s62, 18432
L_tr18:
ds_read_b32 v3, v9 offset:656
s_waitcnt lgkmcnt(0)
v_readfirstlane_b32 s40, v3
s_cmp_eq_u32 s40, 100
s_cbranch_scc1 L_tr18d
s_sleep 2
s_sub_u32 s94, s94, 1
s_cbranch_scc0 L_tr18
L_tr18d:
buffer_load_dwordx4 v[212:215], v30, s[44:47], 0 offen offset:0 nt
buffer_load_dwordx4 v[216:219], v30, s[44:47], 0 offen offset:1152 nt
buffer_load_dwordx4 v[220:223], v30, s[44:47], 0 offen offset:2304 nt
buffer_load_dwordx4 v[224:227], v30, s[44:47], 0 offen offset:3456 nt
buffer_load_dwordx4 v[112:115], v28, s[88:91], 0 offen nt
buffer_load_dwordx4 v[116:119], v28, s[88:91], s48 offen nt
buffer_load_dwordx4 v[120:123], v28, s[88:91], s49 offen nt
buffer_load_dwordx4 v[124:127], v28, s[88:91], s50 offen nt
buffer_load_dwordx4 v[128:131], v28, s[88:91], s62 offen nt
s_barrier
s_branch L_tail
L_s2:
v_and_b32 v3, 1, v10
v_lshlrev_b32 v3, 4, v3
v_mov_b32 v4, 0xffff
v_lshlrev_b32 v4, v3, v4
v_bfe_u32 v3, v10, 1, 2
v_cmp_eq_u32 vcc, 0, v3
s_nop 1
v_cndmask_b32 v12, 0, v4, vcc
v_cmp_eq_u32 vcc, 1, v3
s_nop 1
v_cndmask_b32 v13, 0, v4, vcc
v_cmp_eq_u32 vcc, 2, v3
s_nop 1
v_cndmask_b32 v14, 0, v4, vcc
v_cmp_eq_u32 vcc, 3, v3
s_nop 1
v_cndmask_b32 v15, 0, v4, vcc
v_lshlrev_b32 v2, 4, v0
v_and_b32 v3, 3, v10
v_lshl_add_u32 v3, v11, 2, v3
v_lshlrev_b32 v3, 4, v3
s_mov_b32 s52, 0x000f000f
s_mov_b32 s53, 0x000f000f
s_mov_b32 s54, 0x00f000f0
s_mov_b32 s55, 0x00f000f0
s_mov_b32 s56, 0x0f000f00
s_mov_b32 s57, 0x0f000f00
s_mov_b32 s58, 0xf000f000
s_mov_b32 s59, 0xf000f000
s_mov_b32 s60, 0x3db504f3
s_mov_b32 s61, 0x3fb8aa3b
v_mov_b32 v52, 0xff800000
s_lshl_b32 s40, s28, 9
v_lshlrev_b32 v57, 5, v10
v_lshl_add_u32 v57, v11, 4, v57
v_add_u32 v57, s40, v57
s_lshl_b32 s41, s28, 4
v_mov_b32 v58, s41
s_lshl_b32 s41, s28, 3
v_mov_b32 v9, s41
v_mov_b32 v8, 0
s_waitcnt vmcnt(5)
buffer_load_dwordx4 v[120:123], v1, s[36:39], s50 offen offset:2048 nt
s_waitcnt vmcnt(5)
buffer_load_dwordx4 v[124:127], v1, s[36:39], s50 offen offset:3072 nt
s_add_u32 s50, s50, 131072
s_and_b32 s50, s50, 0x3fffff
s_waitcnt vmcnt(5)
buffer_load_dwordx4 v[128:131], v1, s[36:39], s50 offen offset:0 nt
s_waitcnt vmcnt(5)
buffer_load_dwordx4 v[132:135], v1, s[36:39], s50 offen offset:1024 nt
s_waitcnt vmcnt(5)
buffer_load_dwordx4 v[136:139], v1, s[36:39], s50 offen offset:2048 nt
s_waitcnt vmcnt(5)
buffer_load_dwordx4 v[140:143], v1, s[36:39], s50 offen offset:3072 nt
s_add_u32 s50, s50, 131072
s_and_b32 s50, s50, 0x3fffff
s_waitcnt vmcnt(5)
buffer_load_dwordx4 v[144:147], v1, s[36:39], s50 offen offset:0 nt
s_waitcnt vmcnt(5)
buffer_load_dwordx4 v[148:151], v1, s[36:39], s50 offen offset:1024 nt
s_waitcnt vmcnt(5)
buffer_load_dwordx4 v[152:155], v1, s[36:39], s50 offen offset:2048 nt
s_waitcnt vmcnt(5)
buffer_load_dwordx4 v[156:159], v1, s[36:39], s50 offen offset:3072 nt
s_add_u32 s50, s50, 131072
s_and_b32 s50, s50, 0x3fffff
s_waitcnt vmcnt(5)
buffer_load_dwordx4 v[160:163], v1, s[36:39], s50 offen offset:0 nt
s_waitcnt vmcnt(5)
buffer_load_dwordx4 v[164:167], v1, s[36:39], s50 offen offset:1024 nt
s_waitcnt vmcnt(5)
buffer_load_dwordx4 v[168:171], v1, s[36:39], s50 offen offset:2048 nt
s_waitcnt vmcnt(5)
buffer_load_dwordx4 v[172:175], v1, s[36:39], s50 offen offset:3072 nt
s_add_u32 s50, s50, 131072
s_and_b32 s50, s50, 0x3fffff
s_waitcnt vmcnt(5)
buffer_load_dwordx4 v[176:179], v1, s[36:39], s50 offen offset:0 nt
s_waitcnt vmcnt(5)
buffer_load_dwordx4 v[180:183], v1, s[36:39], s50 offen offset:1024 nt
s_waitcnt vmcnt(5)
buffer_load_dwordx4 v[184:187], v1, s[36:39], s50 offen offset:2048 nt
s_waitcnt vmcnt(5)
buffer_load_dwordx4 v[188:191], v1, s[36:39], s50 offen offset:3072 nt
s_add_u32 s50, s50, 131072
s_and_b32 s50, s50, 0x3fffff
s_waitcnt vmcnt(5)
buffer_load_dwordx4 v[192:195], v1, s[36:39], s50 offen offset:0 nt
s_waitcnt vmcnt(5)
buffer_load_dwordx4 v[196:199], v1, s[36:39], s50 offen offset:1024 nt
s_waitcnt vmcnt(5)
buffer_load_dwordx4 v[200:203], v1, s[36:39], s50 offen offset:2048 nt
s_waitcnt vmcnt(5)
buffer_load_dwordx4 v[204:207], v1, s[36:39], s50 offen offset:3072 nt
s_add_u32 s50, s50, 131072
s_and_b32 s50, s50, 0x3fffff
s_waitcnt vmcnt(5)
buffer_load_dwordx4 v[208:211], v1, s[36:39], s50 offen offset:0 nt
s_waitcnt vmcnt(5)
buffer_load_dwordx4 v[212:215], v1, s[36:39], s50 offen offset:1024 nt
s_waitcnt vmcnt(5)
buffer_load_dwordx4 v[216:219], v1, s[36:39], s50 offen offset:2048 nt
s_waitcnt vmcnt(5)
buffer_load_dwordx4 v[220:223], v1, s[36:39], s50 offen offset:3072 nt
s_add_u32 s50, s50, 131072
s_and_b32 s50, s50, 0x3fffff
s_waitcnt vmcnt(5)
buffer_load_dwordx4 v[224:227], v1, s[36:39], s50 offen offset:0 nt
s_waitcnt vmcnt(5)
buffer_load_dwordx4 v[228:231], v1, s[36:39], s50 offen offset:1024 nt
s_waitcnt vmcnt(5)
buffer_load_dwordx4 v[232:235], v1, s[36:39], s50 offen offset:2048 nt
s_waitcnt vmcnt(5)
buffer_load_dwordx4 v[236:239], v1, s[36:39], s50 offen offset:3072 nt
s_add_u32 s50, s50, 131072
s_and_b32 s50, s50, 0x3fffff
s_waitcnt vmcnt(5)
buffer_load_dwordx4 v[240:243], v1, s[36:39], s50 offen offset:0 nt
s_waitcnt vmcnt(5)
buffer_load_dwordx4 v[244:247], v1, s[36:39], s50 offen offset:1024 nt
s_waitcnt vmcnt(5)
buffer_load_dwordx4 v[248:251], v1, s[36:39], s50 offen offset:2048 nt
s_waitcnt vmcnt(5)
buffer_load_dwordx4 v[252:255], v1, s[36:39], s50 offen offset:3072 nt
s_add_u32 s50, s50, 131072
s_and_b32 s50, s50, 0x3fffff
s_barrier
ds_read_b128 v[4:7], v3 offset:0
ds_read_b32 v8, v8 offset:608
s_waitcnt lgkmcnt(0)
v_cndmask_b32 v16, 0, v4, s[52:53]
v_cndmask_b32 v17, 0, v5, s[52:53]
v_cndmask_b32 v18, 0, v6, s[52:53]
v_cndmask_b32 v19, 0, v7, s[52:53]
v_cndmask_b32 v20, 0, v4, s[54:55]
v_cndmask_b32 v21, 0, v5, s[54:55]
v_cndmask_b32 v22, 0, v6, s[54:55]
v_cndmask_b32 v23, 0, v7, s[54:55]
v_cndmask_b32 v24, 0, v4, s[56:57]
v_cndmask_b32 v25, 0, v5, s[56:57]
v_cndmask_b32 v26, 0, v6, s[56:57]
v_cndmask_b32 v27, 0, v7, s[56:57]
v_cndmask_b32 v28, 0, v4, s[58:59]
v_cndmask_b32 v29, 0, v5, s[58:59]
v_cndmask_b32 v30, 0, v6, s[58:59]
v_cndmask_b32 v31, 0, v7, s[58:59]
v_mov_b32 v53, 0
v_readfirstlane_b32 s42, v8
s_add_u32 s63, s63, 9
s_and_b32 s43, s63, 0x3ff
s_mov_b32 s51, 0xfffffc00
s_and_b32 s96, s63, 0xff
s_mov_b32 s97, 0xffffff00
v_mov_b32 v59, s43
v_mov_b32 v8, 0
s_lshl_b32 s41, s28, 2
v_mov_b32 v3, s41
s_mov_b32 s41, 21
s_waitcnt vmcnt(39)
v_mfma_f32_16x16x32_bf16 v[32:35], v[96:99], v[16:19], 0
s_waitcnt vmcnt(38)
v_mfma_f32_16x16x32_bf16 v[32:35], v[100:103], v[20:23], v[32:35]
s_waitcnt vmcnt(6)
s_cmp_ge_u32 s41, 28
s_cbranch_scc1 L_t19
s_waitcnt vmcnt(5)
s_cmp_ge_u32 s41, 24
s_cbranch_scc1 L_t19
s_waitcnt vmcnt(4)
s_cmp_ge_u32 s41, 20
s_cbranch_scc1 L_t19
s_waitcnt vmcnt(3)
L_t19:
buffer_load_dwordx4 v[96:99], v1, s[36:39], s50 offen offset:0 nt
s_waitcnt vmcnt(38)
v_mfma_f32_16x16x32_bf16 v[32:35], v[104:107], v[24:27], v[32:35]
s_waitcnt vmcnt(37)
v_mfma_f32_16x16x32_bf16 v[32:35], v[108:111], v[28:31], v[32:35]
s_waitcnt vmcnt(6)
s_cmp_ge_u32 s41, 27
s_cbranch_scc1 L_t20
s_waitcnt vmcnt(5)
s_cmp_ge_u32 s41, 23
s_cbranch_scc1 L_t20
s_waitcnt vmcnt(4)
s_cmp_ge_u32 s41, 19
s_cbranch_scc1 L_t20
s_waitcnt vmcnt(3)
L_t20:
buffer_load_dwordx4 v[100:103], v1, s[36:39], s50 offen offset:1024 nt
s_waitcnt lgkmcnt(0)
v_readfirstlane_b32 s41, v11
s_waitcnt vmcnt(37)
v_mfma_f32_16x16x32_bf16 v[36:39], v[112:115], v[16:19], 0
s_waitcnt vmcnt(36)
v_mfma_f32_16x16x32_bf16 v[36:39], v[116:119], v[20:23], v[36:39]
s_waitcnt vmcnt(6)
s_cmp_ge_u32 s41, 26
s_cbranch_scc1 L_t21
s_waitcnt vmcnt(5)
s_cmp_ge_u32 s41, 22
s_cbranch_scc1 L_t21
s_waitcnt vmcnt(4)
s_cmp_ge_u32 s41, 18
s_cbranch_scc1 L_t21
s_waitcnt vmcnt(3)
L_t21:
buffer_load_dwordx4 v[104:107], v1, s[36:39], s50 offen offset:2048 nt
s_waitcnt vmcnt(36)
v_mfma_f32_16x16x32_bf16 v[36:39], v[120:123], v[24:27], v[36:39]
s_waitcnt vmcnt(35)
v_mfma_f32_16x16x32_bf16 v[36:39], v[124:127], v[28:31], v[36:39]
s_waitcnt vmcnt(6)
s_cmp_ge_u32 s41, 25
s_cbranch_scc1 L_t22
s_waitcnt vmcnt(5)
s_cmp_ge_u32 s41, 21
s_cbranch_scc1 L_t22
s_waitcnt vmcnt(4)
s_cmp_ge_u32 s41, 17
s_cbranch_scc1 L_t22
s_waitcnt vmcnt(3)
L_t22:
buffer_load_dwordx4 v[108:111], v1, s[36:39], s50 offen offset:3072 nt
s_add_u32 s50, s50, 131072
s_and_b32 s50, s50, 0x3fffff
v_mov_b32_dpp v60, v32 quad_perm:[0,0,0,0] row_mask:0xf bank_mask:0xf
v_mov_b32_dpp v55, v34 quad_perm:[2,2,2,2] row_mask:0xf bank_mask:0xf
s_nop 0
v_add_f32_dpp v60, v33, v60 quad_perm:[1,1,1,1] row_mask:0xf bank_mask:0xf
v_add_f32_dpp v55, v35, v55 quad_perm:[3,3,3,3] row_mask:0xf bank_mask:0xf
v_add_f32 v60, v60, v55
s_waitcnt vmcnt(35)
v_mfma_f32_16x16x32_bf16 v[32:35], v[128:131], v[16:19], 0
s_waitcnt vmcnt(34)
v_mfma_f32_16x16x32_bf16 v[32:35], v[132:135], v[20:23], v[32:35]
s_waitcnt vmcnt(6)
s_cmp_ge_u32 s41, 28
s_cbranch_scc1 L_t23
s_waitcnt vmcnt(5)
s_cmp_ge_u32 s41, 24
s_cbranch_scc1 L_t23
s_waitcnt vmcnt(4)
s_cmp_ge_u32 s41, 20
s_cbranch_scc1 L_t23
s_waitcnt vmcnt(3)
L_t23:
buffer_load_dwordx4 v[112:115], v1, s[36:39], s50 offen offset:0 nt
s_waitcnt vmcnt(34)
v_mfma_f32_16x16x32_bf16 v[32:35], v[136:139], v[24:27], v[32:35]
s_waitcnt vmcnt(33)
v_mfma_f32_16x16x32_bf16 v[32:35], v[140:143], v[28:31], v[32:35]
s_waitcnt vmcnt(6)
s_cmp_ge_u32 s41, 27
s_cbranch_scc1 L_t24
s_waitcnt vmcnt(5)
s_cmp_ge_u32 s41, 23
s_cbranch_scc1 L_t24
s_waitcnt vmcnt(4)
s_cmp_ge_u32 s41, 19
s_cbranch_scc1 L_t24
s_waitcnt vmcnt(3)
L_t24:
buffer_load_dwordx4 v[116:119], v1, s[36:39], s50 offen offset:1024 nt
v_mov_b32_dpp v61, v36 quad_perm:[0,0,0,0] row_mask:0xf bank_mask:0xf
v_mov_b32_dpp v55, v38 quad_perm:[2,2,2,2] row_mask:0xf bank_mask:0xf
s_nop 0
v_add_f32_dpp v61, v37, v61 quad_perm:[1,1,1,1] row_mask:0xf bank_mask:0xf
v_add_f32_dpp v55, v39, v55 quad_perm:[3,3,3,3] row_mask:0xf bank_mask:0xf
v_add_f32 v61, v61, v55
v_cvt_pk_bf16_f32 v56, v60, v61
v_lshlrev_b32 v60, 16, v56
v_and_b32 v61, 0xffff0000, v56
v_mul_f32 v60, s60, v60
v_mul_f32 v61, s60, v61
v_cvt_pk_bf16_f32 v56, v60, v61
v_lshlrev_b32 v60, 16, v56
v_and_b32 v61, 0xffff0000, v56
v_max3_f32 v52, v52, v60, v61
s_waitcnt vmcnt(33)
v_mfma_f32_16x16x32_bf16 v[36:39], v[144:147], v[16:19], 0
s_waitcnt vmcnt(32)
v_mfma_f32_16x16x32_bf16 v[36:39], v[148:151], v[20:23], v[36:39]
s_waitcnt vmcnt(6)
s_cmp_ge_u32 s41, 26
s_cbranch_scc1 L_t25
s_waitcnt vmcnt(5)
s_cmp_ge_u32 s41, 22
s_cbranch_scc1 L_t25
s_waitcnt vmcnt(4)
s_cmp_ge_u32 s41, 18
s_cbranch_scc1 L_t25
s_waitcnt vmcnt(3)
L_t25:
buffer_load_dwordx4 v[120:123], v1, s[36:39], s50 offen offset:2048 nt
s_waitcnt vmcnt(32)
v_mfma_f32_16x16x32_bf16 v[36:39], v[152:155], v[24:27], v[36:39]
s_waitcnt vmcnt(31)
v_mfma_f32_16x16x32_bf16 v[36:39], v[156:159], v[28:31], v[36:39]
s_waitcnt vmcnt(6)
s_cmp_ge_u32 s41, 25
s_cbranch_scc1 L_t26
s_waitcnt vmcnt(5)
s_cmp_ge_u32 s41, 21
s_cbranch_scc1 L_t26
s_waitcnt vmcnt(4)
s_cmp_ge_u32 s41, 17
s_cbranch_scc1 L_t26
s_waitcnt vmcnt(3)
L_t26:
buffer_load_dwordx4 v[124:127], v1, s[36:39], s50 offen offset:3072 nt
s_add_u32 s50, s50, 131072
s_and_b32 s50, s50, 0x3fffff
v_mov_b32 v56, 0
ds_write_b32 v3, v56 offset:640
ds_read_b32 v11, v8 offset:672
v_mov_b32_dpp v62, v32 quad_perm:[0,0,0,0] row_mask:0xf bank_mask:0xf
v_mov_b32_dpp v55, v34 quad_perm:[2,2,2,2] row_mask:0xf bank_mask:0xf
s_nop 0
v_add_f32_dpp v62, v33, v62 quad_perm:[1,1,1,1] row_mask:0xf bank_mask:0xf
v_add_f32_dpp v55, v35, v55 quad_perm:[3,3,3,3] row_mask:0xf bank_mask:0xf
v_add_f32 v62, v62, v55
s_waitcnt vmcnt(31)
v_mfma_f32_16x16x32_bf16 v[32:35], v[160:163], v[16:19], 0
s_waitcnt vmcnt(30)
v_mfma_f32_16x16x32_bf16 v[32:35], v[164:167], v[20:23], v[32:35]
s_waitcnt vmcnt(6)
s_cmp_ge_u32 s41, 28
s_cbranch_scc1 L_t27
s_waitcnt vmcnt(5)
s_cmp_ge_u32 s41, 24
s_cbranch_scc1 L_t27
s_waitcnt vmcnt(4)
s_cmp_ge_u32 s41, 20
s_cbranch_scc1 L_t27
s_waitcnt vmcnt(3)
L_t27:
buffer_load_dwordx4 v[128:131], v1, s[36:39], s50 offen offset:0 nt
s_waitcnt vmcnt(30)
v_mfma_f32_16x16x32_bf16 v[32:35], v[168:171], v[24:27], v[32:35]
s_waitcnt vmcnt(29)
v_mfma_f32_16x16x32_bf16 v[32:35], v[172:175], v[28:31], v[32:35]
s_waitcnt vmcnt(6)
s_cmp_ge_u32 s41, 27
s_cbranch_scc1 L_t28
s_waitcnt vmcnt(5)
s_cmp_ge_u32 s41, 23
s_cbranch_scc1 L_t28
s_waitcnt vmcnt(4)
s_cmp_ge_u32 s41, 19
s_cbranch_scc1 L_t28
s_waitcnt vmcnt(3)
L_t28:
buffer_load_dwordx4 v[132:135], v1, s[36:39], s50 offen offset:1024 nt
s_waitcnt lgkmcnt(0)
v_readfirstlane_b32 s41, v11
v_mov_b32_dpp v63, v36 quad_perm:[0,0,0,0] row_mask:0xf bank_mask:0xf
v_mov_b32_dpp v55, v38 quad_perm:[2,2,2,2] row_mask:0xf bank_mask:0xf
s_nop 0
v_add_f32_dpp v63, v37, v63 quad_perm:[1,1,1,1] row_mask:0xf bank_mask:0xf
v_add_f32_dpp v55, v39, v55 quad_perm:[3,3,3,3] row_mask:0xf bank_mask:0xf
v_add_f32 v63, v63, v55
v_cvt_pk_bf16_f32 v56, v62, v63
v_lshlrev_b32 v62, 16, v56
v_and_b32 v63, 0xffff0000, v56
v_mul_f32 v62, s60, v62
v_mul_f32 v63, s60, v63
v_cvt_pk_bf16_f32 v56, v62, v63
v_lshlrev_b32 v62, 16, v56
v_and_b32 v63, 0xffff0000, v56
v_max3_f32 v52, v52, v62, v63
s_waitcnt vmcnt(29)
v_mfma_f32_16x16x32_bf16 v[36:39], v[176:179], v[16:19], 0
s_waitcnt vmcnt(28)
v_mfma_f32_16x16x32_bf16 v[36:39], v[180:183], v[20:23], v[36:39]
s_waitcnt vmcnt(6)
s_cmp_ge_u32 s41, 26
s_cbranch_scc1 L_t29
s_waitcnt vmcnt(5)
s_cmp_ge_u32 s41, 22
s_cbranch_scc1 L_t29
s_waitcnt vmcnt(4)
s_cmp_ge_u32 s41, 18
s_cbranch_scc1 L_t29
s_waitcnt vmcnt(3)
L_t29:
buffer_load_dwordx4 v[136:139], v1, s[36:39], s50 offen offset:2048 nt
s_waitcnt vmcnt(28)
v_mfma_f32_16x16x32_bf16 v[36:39], v[184:187], v[24:27], v[36:39]
s_waitcnt vmcnt(27)
v_mfma_f32_16x16x32_bf16 v[36:39], v[188:191], v[28:31], v[36:39]
s_waitcnt vmcnt(6)
s_cmp_ge_u32 s41, 25
s_cbranch_scc1 L_t30
s_waitcnt vmcnt(5)
s_cmp_ge_u32 s41, 21
s_cbranch_scc1 L_t30
s_waitcnt vmcnt(4)
s_cmp_ge_u32 s41, 17
s_cbranch_scc1 L_t30
s_waitcnt vmcnt(3)
L_t30:
buffer_load_dwordx4 v[140:143], v1, s[36:39], s50 offen offset:3072 nt
s_add_u32 s50, s50, 131072
s_and_b32 s50, s50, 0x3fffff
v_mov_b32_dpp v64, v32 quad_perm:[0,0,0,0] row_mask:0xf bank_mask:0xf
v_mov_b32_dpp v55, v34 quad_perm:[2,2,2,2] row_mask:0xf bank_mask:0xf
s_nop 0
v_add_f32_dpp v64, v33, v64 quad_perm:[1,1,1,1] row_mask:0xf bank_mask:0xf
v_add_f32_dpp v55, v35, v55 quad_perm:[3,3,3,3] row_mask:0xf bank_mask:0xf
v_add_f32 v64, v64, v55
s_waitcnt vmcnt(27)
v_mfma_f32_16x16x32_bf16 v[32:35], v[192:195], v[16:19], 0
s_waitcnt vmcnt(26)
v_mfma_f32_16x16x32_bf16 v[32:35], v[196:199], v[20:23], v[32:35]
s_waitcnt vmcnt(6)
s_cmp_ge_u32 s41, 28
s_cbranch_scc1 L_t31
s_waitcnt vmcnt(5)
s_cmp_ge_u32 s41, 24
s_cbranch_scc1 L_t31
s_waitcnt vmcnt(4)
s_cmp_ge_u32 s41, 20
s_cbranch_scc1 L_t31
s_waitcnt vmcnt(3)
L_t31:
buffer_load_dwordx4 v[144:147], v1, s[36:39], s50 offen offset:0 nt
s_waitcnt vmcnt(26)
v_mfma_f32_16x16x32_bf16 v[32:35], v[200:203], v[24:27], v[32:35]
s_waitcnt vmcnt(25)
v_mfma_f32_16x16x32_bf16 v[32:35], v[204:207], v[28:31], v[32:35]
s_waitcnt vmcnt(6)
s_cmp_ge_u32 s41, 27
s_cbranch_scc1 L_t32
s_waitcnt vmcnt(5)
s_cmp_ge_u32 s41, 23
s_cbranch_scc1 L_t32
s_waitcnt vmcnt(4)
s_cmp_ge_u32 s41, 19
s_cbranch_scc1 L_t32
s_waitcnt vmcnt(3)
L_t32:
buffer_load_dwordx4 v[148:151], v1, s[36:39], s50 offen offset:1024 nt
v_mov_b32_dpp v65, v36 quad_perm:[0,0,0,0] row_mask:0xf bank_mask:0xf
v_mov_b32_dpp v55, v38 quad_perm:[2,2,2,2] row_mask:0xf bank_mask:0xf
s_nop 0
v_add_f32_dpp v65, v37, v65 quad_perm:[1,1,1,1] row_mask:0xf bank_mask:0xf
v_add_f32_dpp v55, v39, v55 quad_perm:[3,3,3,3] row_mask:0xf bank_mask:0xf
v_add_f32 v65, v65, v55
v_cvt_pk_bf16_f32 v56, v64, v65
v_lshlrev_b32 v64, 16, v56
v_and_b32 v65, 0xffff0000, v56
v_mul_f32 v64, s60, v64
v_mul_f32 v65, s60, v65
v_cvt_pk_bf16_f32 v56, v64, v65
v_lshlrev_b32 v64, 16, v56
v_and_b32 v65, 0xffff0000, v56
v_max3_f32 v52, v52, v64, v65
s_waitcnt vmcnt(25)
v_mfma_f32_16x16x32_bf16 v[36:39], v[208:211], v[16:19], 0
s_waitcnt vmcnt(24)
v_mfma_f32_16x16x32_bf16 v[36:39], v[212:215], v[20:23], v[36:39]
s_waitcnt vmcnt(6)
s_cmp_ge_u32 s41, 26
s_cbranch_scc1 L_t33
s_waitcnt vmcnt(5)
s_cmp_ge_u32 s41, 22
s_cbranch_scc1 L_t33
s_waitcnt vmcnt(4)
s_cmp_ge_u32 s41, 18
s_cbranch_scc1 L_t33
s_waitcnt vmcnt(3)
L_t33:
buffer_load_dwordx4 v[152:155], v1, s[36:39], s50 offen offset:2048 nt
s_waitcnt vmcnt(24)
v_mfma_f32_16x16x32_bf16 v[36:39], v[216:219], v[24:27], v[36:39]
s_waitcnt vmcnt(23)
v_mfma_f32_16x16x32_bf16 v[36:39], v[220:223], v[28:31], v[36:39]
s_waitcnt vmcnt(6)
s_cmp_ge_u32 s41, 25
s_cbranch_scc1 L_t34
s_waitcnt vmcnt(5)
s_cmp_ge_u32 s41, 21
s_cbranch_scc1 L_t34
s_waitcnt vmcnt(4)
s_cmp_ge_u32 s41, 17
s_cbranch_scc1 L_t34
s_waitcnt vmcnt(3)
L_t34:
buffer_load_dwordx4 v[156:159], v1, s[36:39], s50 offen offset:3072 nt
s_add_u32 s50, s50, 131072
s_and_b32 s50, s50, 0x3fffff
ds_read_b32 v11, v8 offset:672
v_mov_b32_dpp v66, v32 quad_perm:[0,0,0,0] row_mask:0xf bank_mask:0xf
v_mov_b32_dpp v55, v34 quad_perm:[2,2,2,2] row_mask:0xf bank_mask:0xf
s_nop 0
v_add_f32_dpp v66, v33, v66 quad_perm:[1,1,1,1] row_mask:0xf bank_mask:0xf
v_add_f32_dpp v55, v35, v55 quad_perm:[3,3,3,3] row_mask:0xf bank_mask:0xf
v_add_f32 v66, v66, v55
s_waitcnt vmcnt(23)
v_mfma_f32_16x16x32_bf16 v[32:35], v[224:227], v[16:19], 0
s_waitcnt vmcnt(22)
v_mfma_f32_16x16x32_bf16 v[32:35], v[228:231], v[20:23], v[32:35]
s_waitcnt vmcnt(6)
s_cmp_ge_u32 s41, 28
s_cbranch_scc1 L_t35
s_waitcnt vmcnt(5)
s_cmp_ge_u32 s41, 24
s_cbranch_scc1 L_t35
s_waitcnt vmcnt(4)
s_cmp_ge_u32 s41, 20
s_cbranch_scc1 L_t35
s_waitcnt vmcnt(3)
L_t35:
buffer_load_dwordx4 v[160:163], v1, s[36:39], s50 offen offset:0 nt
s_waitcnt vmcnt(22)
v_mfma_f32_16x16x32_bf16 v[32:35], v[232:235], v[24:27], v[32:35]
s_waitcnt vmcnt(21)
v_mfma_f32_16x16x32_bf16 v[32:35], v[236:239], v[28:31], v[32:35]
s_waitcnt vmcnt(6)
s_cmp_ge_u32 s41, 27
s_cbranch_scc1 L_t36
s_waitcnt vmcnt(5)
s_cmp_ge_u32 s41, 23
s_cbranch_scc1 L_t36
s_waitcnt vmcnt(4)
s_cmp_ge_u32 s41, 19
s_cbranch_scc1 L_t36
s_waitcnt vmcnt(3)
L_t36:
buffer_load_dwordx4 v[164:167], v1, s[36:39], s50 offen offset:1024 nt
s_waitcnt lgkmcnt(0)
v_readfirstlane_b32 s41, v11
v_mov_b32_dpp v67, v36 quad_perm:[0,0,0,0] row_mask:0xf bank_mask:0xf
v_mov_b32_dpp v55, v38 quad_perm:[2,2,2,2] row_mask:0xf bank_mask:0xf
s_nop 0
v_add_f32_dpp v67, v37, v67 quad_perm:[1,1,1,1] row_mask:0xf bank_mask:0xf
v_add_f32_dpp v55, v39, v55 quad_perm:[3,3,3,3] row_mask:0xf bank_mask:0xf
v_add_f32 v67, v67, v55
v_cvt_pk_bf16_f32 v56, v66, v67
v_lshlrev_b32 v66, 16, v56
v_and_b32 v67, 0xffff0000, v56
v_mul_f32 v66, s60, v66
v_mul_f32 v67, s60, v67
v_cvt_pk_bf16_f32 v56, v66, v67
v_lshlrev_b32 v66, 16, v56
v_and_b32 v67, 0xffff0000, v56
v_max3_f32 v52, v52, v66, v67
s_waitcnt vmcnt(21)
v_mfma_f32_16x16x32_bf16 v[36:39], v[240:243], v[16:19], 0
s_waitcnt vmcnt(20)
v_mfma_f32_16x16x32_bf16 v[36:39], v[244:247], v[20:23], v[36:39]
s_waitcnt vmcnt(6)
s_cmp_ge_u32 s41, 26
s_cbranch_scc1 L_t37
s_waitcnt vmcnt(5)
s_cmp_ge_u32 s41, 22
s_cbranch_scc1 L_t37
s_waitcnt vmcnt(4)
s_cmp_ge_u32 s41, 18
s_cbranch_scc1 L_t37
s_waitcnt vmcnt(3)
L_t37:
buffer_load_dwordx4 v[168:171], v1, s[36:39], s50 offen offset:2048 nt
s_waitcnt vmcnt(20)
v_mfma_f32_16x16x32_bf16 v[36:39], v[248:251], v[24:27], v[36:39]
s_waitcnt vmcnt(19)
v_mfma_f32_16x16x32_bf16 v[36:39], v[252:255], v[28:31], v[36:39]
s_waitcnt vmcnt(6)
s_cmp_ge_u32 s41, 25
s_cbranch_scc1 L_t38
s_waitcnt vmcnt(5)
s_cmp_ge_u32 s41, 21
s_cbranch_scc1 L_t38
s_waitcnt vmcnt(4)
s_cmp_ge_u32 s41, 17
s_cbranch_scc1 L_t38
s_waitcnt vmcnt(3)
L_t38:
buffer_load_dwordx4 v[172:175], v1, s[36:39], s50 offen offset:3072 nt
s_add_u32 s50, s50, 131072
s_and_b32 s50, s50, 0x3fffff
v_mov_b32_dpp v68, v32 quad_perm:[0,0,0,0] row_mask:0xf bank_mask:0xf
v_mov_b32_dpp v55, v34 quad_perm:[2,2,2,2] row_mask:0xf bank_mask:0xf
s_nop 0
v_add_f32_dpp v68, v33, v68 quad_perm:[1,1,1,1] row_mask:0xf bank_mask:0xf
v_add_f32_dpp v55, v35, v55 quad_perm:[3,3,3,3] row_mask:0xf bank_mask:0xf
v_add_f32 v68, v68, v55
s_waitcnt vmcnt(19)
v_mfma_f32_16x16x32_bf16 v[32:35], v[96:99], v[16:19], 0
s_waitcnt vmcnt(18)
v_mfma_f32_16x16x32_bf16 v[32:35], v[100:103], v[20:23], v[32:35]
s_waitcnt vmcnt(6)
s_cmp_ge_u32 s41, 28
s_cbranch_scc1 L_t39
s_waitcnt vmcnt(5)
s_cmp_ge_u32 s41, 24
s_cbranch_scc1 L_t39
s_waitcnt vmcnt(4)
s_cmp_ge_u32 s41, 20
s_cbranch_scc1 L_t39
s_waitcnt vmcnt(3)
L_t39:
buffer_load_dwordx4 v[176:179], v1, s[36:39], s50 offen offset:0 nt
s_waitcnt vmcnt(18)
v_mfma_f32_16x16x32_bf16 v[32:35], v[104:107], v[24:27], v[32:35]
s_waitcnt vmcnt(17)
v_mfma_f32_16x16x32_bf16 v[32:35], v[108:111], v[28:31], v[32:35]
s_waitcnt vmcnt(6)
s_cmp_ge_u32 s41, 27
s_cbranch_scc1 L_t40
s_waitcnt vmcnt(5)
s_cmp_ge_u32 s41, 23
s_cbranch_scc1 L_t40
s_waitcnt vmcnt(4)
s_cmp_ge_u32 s41, 19
s_cbranch_scc1 L_t40
s_waitcnt vmcnt(3)
L_t40:
buffer_load_dwordx4 v[180:183], v1, s[36:39], s50 offen offset:1024 nt
v_mov_b32_dpp v69, v36 quad_perm:[0,0,0,0] row_mask:0xf bank_mask:0xf
v_mov_b32_dpp v55, v38 quad_perm:[2,2,2,2] row_mask:0xf bank_mask:0xf
s_nop 0
v_add_f32_dpp v69, v37, v69 quad_perm:[1,1,1,1] row_mask:0xf bank_mask:0xf
v_add_f32_dpp v55, v39, v55 quad_perm:[3,3,3,3] row_mask:0xf bank_mask:0xf
v_add_f32 v69, v69, v55
v_cvt_pk_bf16_f32 v56, v68, v69
v_lshlrev_b32 v68, 16, v56
v_and_b32 v69, 0xffff0000, v56
v_mul_f32 v68, s60, v68
v_mul_f32 v69, s60, v69
v_cvt_pk_bf16_f32 v56, v68, v69
v_lshlrev_b32 v68, 16, v56
v_and_b32 v69, 0xffff0000, v56
v_max3_f32 v52, v52, v68, v69
s_waitcnt vmcnt(17)
v_mfma_f32_16x16x32_bf16 v[36:39], v[112:115], v[16:19], 0
s_waitcnt vmcnt(16)
v_mfma_f32_16x16x32_bf16 v[36:39], v[116:119], v[20:23], v[36:39]
s_waitcnt vmcnt(6)
s_cmp_ge_u32 s41, 26
s_cbranch_scc1 L_t41
s_waitcnt vmcnt(5)
s_cmp_ge_u32 s41, 22
s_cbranch_scc1 L_t41
s_waitcnt vmcnt(4)
s_cmp_ge_u32 s41, 18
s_cbranch_scc1 L_t41
s_waitcnt vmcnt(3)
L_t41:
buffer_load_dwordx4 v[184:187], v1, s[36:39], s50 offen offset:2048 nt
s_waitcnt vmcnt(16)
v_mfma_f32_16x16x32_bf16 v[36:39], v[120:123], v[24:27], v[36:39]
s_waitcnt vmcnt(15)
v_mfma_f32_16x16x32_bf16 v[36:39], v[124:127], v[28:31], v[36:39]
s_waitcnt vmcnt(6)
s_cmp_ge_u32 s41, 25
s_cbranch_scc1 L_t42
s_waitcnt vmcnt(5)
s_cmp_ge_u32 s41, 21
s_cbranch_scc1 L_t42
s_waitcnt vmcnt(4)
s_cmp_ge_u32 s41, 17
s_cbranch_scc1 L_t42
s_waitcnt vmcnt(3)
L_t42:
buffer_load_dwordx4 v[188:191], v1, s[36:39], s50 offen offset:3072 nt
s_add_u32 s50, s50, 131072
s_and_b32 s50, s50, 0x3fffff
v_mov_b32 v56, 1
ds_write_b32 v3, v56 offset:640
ds_read_b32 v11, v8 offset:672
v_mov_b32_dpp v70, v32 quad_perm:[0,0,0,0] row_mask:0xf bank_mask:0xf
v_mov_b32_dpp v55, v34 quad_perm:[2,2,2,2] row_mask:0xf bank_mask:0xf
s_nop 0
v_add_f32_dpp v70, v33, v70 quad_perm:[1,1,1,1] row_mask:0xf bank_mask:0xf
v_add_f32_dpp v55, v35, v55 quad_perm:[3,3,3,3] row_mask:0xf bank_mask:0xf
v_add_f32 v70, v70, v55
s_waitcnt vmcnt(15)
v_mfma_f32_16x16x32_bf16 v[32:35], v[128:131], v[16:19], 0
s_waitcnt vmcnt(14)
v_mfma_f32_16x16x32_bf16 v[32:35], v[132:135], v[20:23], v[32:35]
s_waitcnt vmcnt(6)
s_cmp_ge_u32 s41, 28
s_cbranch_scc1 L_t43
s_waitcnt vmcnt(5)
s_cmp_ge_u32 s41, 24
s_cbranch_scc1 L_t43
s_waitcnt vmcnt(4)
s_cmp_ge_u32 s41, 20
s_cbranch_scc1 L_t43
s_waitcnt vmcnt(3)
L_t43:
buffer_load_dwordx4 v[192:195], v1, s[36:39], s50 offen offset:0 nt
s_waitcnt vmcnt(14)
v_mfma_f32_16x16x32_bf16 v[32:35], v[136:139], v[24:27], v[32:35]
s_waitcnt vmcnt(13)
v_mfma_f32_16x16x32_bf16 v[32:35], v[140:143], v[28:31], v[32:35]
s_waitcnt vmcnt(6)
s_cmp_ge_u32 s41, 27
s_cbranch_scc1 L_t44
s_waitcnt vmcnt(5)
s_cmp_ge_u32 s41, 23
s_cbranch_scc1 L_t44
s_waitcnt vmcnt(4)
s_cmp_ge_u32 s41, 19
s_cbranch_scc1 L_t44
s_waitcnt vmcnt(3)
L_t44:
buffer_load_dwordx4 v[196:199], v1, s[36:39], s50 offen offset:1024 nt
s_waitcnt lgkmcnt(0)
v_readfirstlane_b32 s41, v11
v_mov_b32_dpp v71, v36 quad_perm:[0,0,0,0] row_mask:0xf bank_mask:0xf
v_mov_b32_dpp v55, v38 quad_perm:[2,2,2,2] row_mask:0xf bank_mask:0xf
s_nop 0
v_add_f32_dpp v71, v37, v71 quad_perm:[1,1,1,1] row_mask:0xf bank_mask:0xf
v_add_f32_dpp v55, v39, v55 quad_perm:[3,3,3,3] row_mask:0xf bank_mask:0xf
v_add_f32 v71, v71, v55
v_cvt_pk_bf16_f32 v56, v70, v71
v_lshlrev_b32 v70, 16, v56
v_and_b32 v71, 0xffff0000, v56
v_mul_f32 v70, s60, v70
v_mul_f32 v71, s60, v71
v_cvt_pk_bf16_f32 v56, v70, v71
v_lshlrev_b32 v70, 16, v56
v_and_b32 v71, 0xffff0000, v56
v_max3_f32 v52, v52, v70, v71
s_waitcnt vmcnt(13)
v_mfma_f32_16x16x32_bf16 v[36:39], v[144:147], v[16:19], 0
s_waitcnt vmcnt(12)
v_mfma_f32_16x16x32_bf16 v[36:39], v[148:151], v[20:23], v[36:39]
s_waitcnt vmcnt(6)
s_cmp_ge_u32 s41, 26
s_cbranch_scc1 L_t45
s_waitcnt vmcnt(5)
s_cmp_ge_u32 s41, 22
s_cbranch_scc1 L_t45
s_waitcnt vmcnt(4)
s_cmp_ge_u32 s41, 18
s_cbranch_scc1 L_t45
s_waitcnt vmcnt(3)
L_t45:
buffer_load_dwordx4 v[200:203], v1, s[36:39], s50 offen offset:2048 nt
s_waitcnt vmcnt(12)
v_mfma_f32_16x16x32_bf16 v[36:39], v[152:155], v[24:27], v[36:39]
s_waitcnt vmcnt(11)
v_mfma_f32_16x16x32_bf16 v[36:39], v[156:159], v[28:31], v[36:39]
s_waitcnt vmcnt(6)
s_cmp_ge_u32 s41, 25
s_cbranch_scc1 L_t46
s_waitcnt vmcnt(5)
s_cmp_ge_u32 s41, 21
s_cbranch_scc1 L_t46
s_waitcnt vmcnt(4)
s_cmp_ge_u32 s41, 17
s_cbranch_scc1 L_t46
s_waitcnt vmcnt(3)
L_t46:
buffer_load_dwordx4 v[204:207], v1, s[36:39], s50 offen offset:3072 nt
s_add_u32 s50, s50, 131072
s_and_b32 s50, s50, 0x3fffff
v_mov_b32_dpp v72, v32 quad_perm:[0,0,0,0] row_mask:0xf bank_mask:0xf
v_mov_b32_dpp v55, v34 quad_perm:[2,2,2,2] row_mask:0xf bank_mask:0xf
s_nop 0
v_add_f32_dpp v72, v33, v72 quad_perm:[1,1,1,1] row_mask:0xf bank_mask:0xf
v_add_f32_dpp v55, v35, v55 quad_perm:[3,3,3,3] row_mask:0xf bank_mask:0xf
v_add_f32 v72, v72, v55
s_waitcnt vmcnt(11)
v_mfma_f32_16x16x32_bf16 v[32:35], v[160:163], v[16:19], 0
s_waitcnt vmcnt(10)
v_mfma_f32_16x16x32_bf16 v[32:35], v[164:167], v[20:23], v[32:35]
s_waitcnt vmcnt(6)
s_cmp_ge_u32 s41, 28
s_cbranch_scc1 L_t47
s_waitcnt vmcnt(5)
s_cmp_ge_u32 s41, 24
s_cbranch_scc1 L_t47
s_waitcnt vmcnt(4)
s_cmp_ge_u32 s41, 20
s_cbranch_scc1 L_t47
s_waitcnt vmcnt(3)
L_t47:
buffer_load_dwordx4 v[208:211], v1, s[36:39], s50 offen offset:0 nt
s_waitcnt vmcnt(10)
v_mfma_f32_16x16x32_bf16 v[32:35], v[168:171], v[24:27], v[32:35]
s_waitcnt vmcnt(9)
v_mfma_f32_16x16x32_bf16 v[32:35], v[172:175], v[28:31], v[32:35]
s_waitcnt vmcnt(6)
s_cmp_ge_u32 s41, 27
s_cbranch_scc1 L_t48
s_waitcnt vmcnt(5)
s_cmp_ge_u32 s41, 23
s_cbranch_scc1 L_t48
s_waitcnt vmcnt(4)
s_cmp_ge_u32 s41, 19
s_cbranch_scc1 L_t48
s_waitcnt vmcnt(3)
L_t48:
buffer_load_dwordx4 v[212:215], v1, s[36:39], s50 offen offset:1024 nt
v_mov_b32_dpp v73, v36 quad_perm:[0,0,0,0] row_mask:0xf bank_mask:0xf
v_mov_b32_dpp v55, v38 quad_perm:[2,2,2,2] row_mask:0xf bank_mask:0xf
s_nop 0
v_add_f32_dpp v73, v37, v73 quad_perm:[1,1,1,1] row_mask:0xf bank_mask:0xf
v_add_f32_dpp v55, v39, v55 quad_perm:[3,3,3,3] row_mask:0xf bank_mask:0xf
v_add_f32 v73, v73, v55
v_cvt_pk_bf16_f32 v56, v72, v73
v_lshlrev_b32 v72, 16, v56
v_and_b32 v73, 0xffff0000, v56
v_mul_f32 v72, s60, v72
v_mul_f32 v73, s60, v73
v_cvt_pk_bf16_f32 v56, v72, v73
v_lshlrev_b32 v72, 16, v56
v_and_b32 v73, 0xffff0000, v56
v_max3_f32 v52, v52, v72, v73
s_waitcnt vmcnt(9)
v_mfma_f32_16x16x32_bf16 v[36:39], v[176:179], v[16:19], 0
s_waitcnt vmcnt(8)
v_mfma_f32_16x16x32_bf16 v[36:39], v[180:183], v[20:23], v[36:39]
s_waitcnt vmcnt(6)
s_cmp_ge_u32 s41, 26
s_cbranch_scc1 L_t49
s_waitcnt vmcnt(5)
s_cmp_ge_u32 s41, 22
s_cbranch_scc1 L_t49
s_waitcnt vmcnt(4)
s_cmp_ge_u32 s41, 18
s_cbranch_scc1 L_t49
s_waitcnt vmcnt(3)
L_t49:
buffer_load_dwordx4 v[216:219], v1, s[36:39], s50 offen offset:2048 nt
s_waitcnt vmcnt(8)
v_mfma_f32_16x16x32_bf16 v[36:39], v[184:187], v[24:27], v[36:39]
s_waitcnt vmcnt(7)
v_mfma_f32_16x16x32_bf16 v[36:39], v[188:191], v[28:31], v[36:39]
s_waitcnt vmcnt(6)
s_cmp_ge_u32 s41, 25
s_cbranch_scc1 L_t50
s_waitcnt vmcnt(5)
s_cmp_ge_u32 s41, 21
s_cbranch_scc1 L_t50
s_waitcnt vmcnt(4)
s_cmp_ge_u32 s41, 17
s_cbranch_scc1 L_t50
s_waitcnt vmcnt(3)
L_t50:
buffer_load_dwordx4 v[220:223], v1, s[36:39], s50 offen offset:3072 nt
s_add_u32 s50, s50, 131072
s_and_b32 s50, s50, 0x3fffff
ds_read_b32 v11, v8 offset:672
v_mov_b32_dpp v74, v32 quad_perm:[0,0,0,0] row_mask:0xf bank_mask:0xf
v_mov_b32_dpp v55, v34 quad_perm:[2,2,2,2] row_mask:0xf bank_mask:0xf
s_nop 0
v_add_f32_dpp v74, v33, v74 quad_perm:[1,1,1,1] row_mask:0xf bank_mask:0xf
v_add_f32_dpp v55, v35, v55 quad_perm:[3,3,3,3] row_mask:0xf bank_mask:0xf
v_add_f32 v74, v74, v55
s_waitcnt vmcnt(7)
v_mfma_f32_16x16x32_bf16 v[32:35], v[192:195], v[16:19], 0
s_waitcnt vmcnt(6)
v_mfma_f32_16x16x32_bf16 v[32:35], v[196:199], v[20:23], v[32:35]
s_cmp_ge_u32 s41, 28
s_cbranch_scc1 L_t51
s_waitcnt vmcnt(5)
s_cmp_ge_u32 s41, 24
s_cbranch_scc1 L_t51
s_waitcnt vmcnt(4)
s_cmp_ge_u32 s41, 20
s_cbranch_scc1 L_t51
s_waitcnt vmcnt(3)
L_t51:
buffer_load_dwordx4 v[224:227], v1, s[36:39], s50 offen offset:0 nt
s_waitcnt vmcnt(6)
v_mfma_f32_16x16x32_bf16 v[32:35], v[200:203], v[24:27], v[32:35]
s_cmp_ge_u32 s41, 27
s_cbranch_scc1 L_t52
s_waitcnt vmcnt(5)
s_cmp_ge_u32 s41, 23
s_cbranch_scc1 L_t52
s_waitcnt vmcnt(4)
s_cmp_ge_u32 s41, 19
s_cbranch_scc1 L_t52
s_waitcnt vmcnt(3)
L_t52:
buffer_load_dwordx4 v[228:231], v1, s[36:39], s50 offen offset:1024 nt
s_waitcnt lgkmcnt(0)
v_readfirstlane_b32 s41, v11
s_waitcnt vmcnt(6)
v_mfma_f32_16x16x32_bf16 v[32:35], v[204:207], v[28:31], v[32:35]
s_cmp_ge_u32 s41, 26
s_cbranch_scc1 L_t53
s_waitcnt vmcnt(5)
s_cmp_ge_u32 s41, 22
s_cbranch_scc1 L_t53
s_waitcnt vmcnt(4)
s_cmp_ge_u32 s41, 18
s_cbranch_scc1 L_t53
s_waitcnt vmcnt(3)
L_t53:
buffer_load_dwordx4 v[232:235], v1, s[36:39], s50 offen offset:2048 nt
v_mov_b32_dpp v75, v36 quad_perm:[0,0,0,0] row_mask:0xf bank_mask:0xf
v_mov_b32_dpp v55, v38 quad_perm:[2,2,2,2] row_mask:0xf bank_mask:0xf
s_nop 0
v_add_f32_dpp v75, v37, v75 quad_perm:[1,1,1,1] row_mask:0xf bank_mask:0xf
v_add_f32_dpp v55, v39, v55 quad_perm:[3,3,3,3] row_mask:0xf bank_mask:0xf
v_add_f32 v75, v75, v55
v_cvt_pk_bf16_f32 v56, v74, v75
v_lshlrev_b32 v74, 16, v56
v_and_b32 v75, 0xffff0000, v56
v_mul_f32 v74, s60, v74
v_mul_f32 v75, s60, v75
v_cvt_pk_bf16_f32 v56, v74, v75
v_lshlrev_b32 v74, 16, v56
v_and_b32 v75, 0xffff0000, v56
v_max3_f32 v52, v52, v74, v75
s_waitcnt vmcnt(6)
v_mfma_f32_16x16x32_bf16 v[36:39], v[208:211], v[16:19], 0
s_cmp_ge_u32 s41, 25
s_cbranch_scc1 L_t54
s_waitcnt vmcnt(5)
s_cmp_ge_u32 s41, 21
s_cbranch_scc1 L_t54
s_waitcnt vmcnt(4)
s_cmp_ge_u32 s41, 17
s_cbranch_scc1 L_t54
s_waitcnt vmcnt(3)
L_t54:
buffer_load_dwordx4 v[236:239], v1, s[36:39], s50 offen offset:3072 nt
s_add_u32 s50, s50, 131072
s_and_b32 s50, s50, 0x3fffff
s_waitcnt vmcnt(6)
v_mfma_f32_16x16x32_bf16 v[36:39], v[212:215], v[20:23], v[36:39]
s_cmp_ge_u32 s41, 28
s_cbranch_scc1 L_t55
s_waitcnt vmcnt(5)
s_cmp_ge_u32 s41, 24
s_cbranch_scc1 L_t55
s_waitcnt vmcnt(4)
s_cmp_ge_u32 s41, 20
s_cbranch_scc1 L_t55
s_waitcnt vmcnt(3)
L_t55:
buffer_load_dwordx4 v[240:243], v1, s[36:39], s50 offen offset:0 nt
s_waitcnt vmcnt(6)
v_mfma_f32_16x16x32_bf16 v[36:39], v[216:219], v[24:27], v[36:39]
s_cmp_ge_u32 s41, 27
s_cbranch_scc1 L_t56
s_waitcnt vmcnt(5)
s_cmp_ge_u32 s41, 23
s_cbranch_scc1 L_t56
s_waitcnt vmcnt(4)
s_cmp_ge_u32 s41, 19
s_cbranch_scc1 L_t56
s_waitcnt vmcnt(3)
L_t56:
buffer_load_dwordx4 v[244:247], v1, s[36:39], s50 offen offset:1024 nt
s_waitcnt vmcnt(6)
v_mfma_f32_16x16x32_bf16 v[36:39], v[220:223], v[28:31], v[36:39]
s_cmp_ge_u32 s41, 26
s_cbranch_scc1 L_t57
s_waitcnt vmcnt(5)
s_cmp_ge_u32 s41, 22
s_cbranch_scc1 L_t57
s_waitcnt vmcnt(4)
s_cmp_ge_u32 s41, 18
s_cbranch_scc1 L_t57
s_waitcnt vmcnt(3)
L_t57:
buffer_load_dwordx4 v[248:251], v1, s[36:39], s50 offen offset:2048 nt
v_mov_b32_dpp v76, v32 quad_perm:[0,0,0,0] row_mask:0xf bank_mask:0xf
v_mov_b32_dpp v55, v34 quad_perm:[2,2,2,2] row_mask:0xf bank_mask:0xf
s_nop 0
v_add_f32_dpp v76, v33, v76 quad_perm:[1,1,1,1] row_mask:0xf bank_mask:0xf
v_add_f32_dpp v55, v35, v55 quad_perm:[3,3,3,3] row_mask:0xf bank_mask:0xf
v_add_f32 v76, v76, v55
s_waitcnt vmcnt(6)
v_mfma_f32_16x16x32_bf16 v[32:35], v[224:227], v[16:19], 0
s_cmp_ge_u32 s41, 25
s_cbranch_scc1 L_t58
s_waitcnt vmcnt(5)
s_cmp_ge_u32 s41, 21
s_cbranch_scc1 L_t58
s_waitcnt vmcnt(4)
s_cmp_ge_u32 s41, 17
s_cbranch_scc1 L_t58
s_waitcnt vmcnt(3)
L_t58:
buffer_load_dwordx4 v[252:255], v1, s[36:39], s50 offen offset:3072 nt
s_add_u32 s50, s50, 131072
s_and_b32 s50, s50, 0x3fffff
v_mov_b32 v56, 2
ds_write_b32 v3, v56 offset:640
ds_read_b32 v11, v8 offset:672
s_waitcnt vmcnt(6)
v_mfma_f32_16x16x32_bf16 v[32:35], v[228:231], v[20:23], v[32:35]
s_cmp_ge_u32 s41, 28
s_cbranch_scc1 L_t59
s_waitcnt vmcnt(5)
s_cmp_ge_u32 s41, 24
s_cbranch_scc1 L_t59
s_waitcnt vmcnt(4)
s_cmp_ge_u32 s41, 20
s_cbranch_scc1 L_t59
s_waitcnt vmcnt(3)
L_t59:
buffer_load_dwordx4 v[96:99], v1, s[36:39], s50 offen offset:0 nt
s_waitcnt vmcnt(6)
v_mfma_f32_16x16x32_bf16 v[32:35], v[232:235], v[24:27], v[32:35]
s_cmp_ge_u32 s41, 27
s_cbranch_scc1 L_t60
s_waitcnt vmcnt(5)
s_cmp_ge_u32 s41, 23
s_cbranch_scc1 L_t60
s_waitcnt vmcnt(4)
s_cmp_ge_u32 s41, 19
s_cbranch_scc1 L_t60
s_waitcnt vmcnt(3)
L_t60:
buffer_load_dwordx4 v[100:103], v1, s[36:39], s50 offen offset:1024 nt
s_waitcnt lgkmcnt(0)
v_readfirstlane_b32 s41, v11
s_waitcnt vmcnt(6)
v_mfma_f32_16x16x32_bf16 v[32:35], v[236:239], v[28:31], v[32:35]
s_cmp_ge_u32 s41, 26
s_cbranch_scc1 L_t61
s_waitcnt vmcnt(5)
s_cmp_ge_u32 s41, 22
s_cbranch_scc1 L_t61
s_waitcnt vmcnt(4)
s_cmp_ge_u32 s41, 18
s_cbranch_scc1 L_t61
s_waitcnt vmcnt(3)
L_t61:
buffer_load_dwordx4 v[104:107], v1, s[36:39], s50 offen offset:2048 nt
v_mov_b32_dpp v77, v36 quad_perm:[0,0,0,0] row_mask:0xf bank_mask:0xf
v_mov_b32_dpp v55, v38 quad_perm:[2,2,2,2] row_mask:0xf bank_mask:0xf
s_nop 0
v_add_f32_dpp v77, v37, v77 quad_perm:[1,1,1,1] row_mask:0xf bank_mask:0xf
v_add_f32_dpp v55, v39, v55 quad_perm:[3,3,3,3] row_mask:0xf bank_mask:0xf
v_add_f32 v77, v77, v55
v_cvt_pk_bf16_f32 v56, v76, v77
v_lshlrev_b32 v76, 16, v56
v_and_b32 v77, 0xffff0000, v56
v_mul_f32 v76, s60, v76
v_mul_f32 v77, s60, v77
v_cvt_pk_bf16_f32 v56, v76, v77
v_lshlrev_b32 v76, 16, v56
v_and_b32 v77, 0xffff0000, v56
v_max3_f32 v52, v52, v76, v77
s_waitcnt vmcnt(6)
v_mfma_f32_16x16x32_bf16 v[36:39], v[240:243], v[16:19], 0
s_cmp_ge_u32 s41, 25
s_cbranch_scc1 L_t62
s_waitcnt vmcnt(5)
s_cmp_ge_u32 s41, 21
s_cbranch_scc1 L_t62
s_waitcnt vmcnt(4)
s_cmp_ge_u32 s41, 17
s_cbranch_scc1 L_t62
s_waitcnt vmcnt(3)
L_t62:
buffer_load_dwordx4 v[108:111], v1, s[36:39], s50 offen offset:3072 nt
s_add_u32 s50, s50, 131072
s_and_b32 s50, s50, 0x3fffff
s_waitcnt vmcnt(6)
v_mfma_f32_16x16x32_bf16 v[36:39], v[244:247], v[20:23], v[36:39]
s_cmp_ge_u32 s41, 28
s_cbranch_scc1 L_t63
s_waitcnt vmcnt(5)
s_cmp_ge_u32 s41, 24
s_cbranch_scc1 L_t63
s_waitcnt vmcnt(4)
s_cmp_ge_u32 s41, 20
s_cbranch_scc1 L_t63
s_waitcnt vmcnt(3)
L_t63:
buffer_load_dwordx4 v[112:115], v1, s[36:39], s50 offen offset:0 nt
s_waitcnt vmcnt(6)
v_mfma_f32_16x16x32_bf16 v[36:39], v[248:251], v[24:27], v[36:39]
s_cmp_ge_u32 s41, 27
s_cbranch_scc1 L_t64
s_waitcnt vmcnt(5)
s_cmp_ge_u32 s41, 23
s_cbranch_scc1 L_t64
s_waitcnt vmcnt(4)
s_cmp_ge_u32 s41, 19
s_cbranch_scc1 L_t64
s_waitcnt vmcnt(3)
L_t64:
buffer_load_dwordx4 v[116:119], v1, s[36:39], s50 offen offset:1024 nt
s_waitcnt vmcnt(6)
v_mfma_f32_16x16x32_bf16 v[36:39], v[252:255], v[28:31], v[36:39]
s_cmp_ge_u32 s41, 26
s_cbranch_scc1 L_t65
s_waitcnt vmcnt(5)
s_cmp_ge_u32 s41, 22
s_cbranch_scc1 L_t65
s_waitcnt vmcnt(4)
s_cmp_ge_u32 s41, 18
s_cbranch_scc1 L_t65
s_waitcnt vmcnt(3)
L_t65:
buffer_load_dwordx4 v[120:123], v1, s[36:39], s50 offen offset:2048 nt
v_mov_b32_dpp v78, v32 quad_perm:[0,0,0,0] row_mask:0xf bank_mask:0xf
v_mov_b32_dpp v55, v34 quad_perm:[2,2,2,2] row_mask:0xf bank_mask:0xf
s_nop 0
v_add_f32_dpp v78, v33, v78 quad_perm:[1,1,1,1] row_mask:0xf bank_mask:0xf
v_add_f32_dpp v55, v35, v55 quad_perm:[3,3,3,3] row_mask:0xf bank_mask:0xf
v_add_f32 v78, v78, v55
s_waitcnt vmcnt(6)
v_mfma_f32_16x16x32_bf16 v[32:35], v[96:99], v[16:19], 0
s_cmp_ge_u32 s41, 25
s_cbranch_scc1 L_t66
s_waitcnt vmcnt(5)
s_cmp_ge_u32 s41, 21
s_cbranch_scc1 L_t66
s_waitcnt vmcnt(4)
s_cmp_ge_u32 s41, 17
s_cbranch_scc1 L_t66
s_waitcnt vmcnt(3)
L_t66:
buffer_load_dwordx4 v[124:127], v1, s[36:39], s50 offen offset:3072 nt
s_add_u32 s50, s50, 131072
s_and_b32 s50, s50, 0x3fffff
ds_read_b32 v11, v8 offset:672
s_waitcnt vmcnt(6)
v_mfma_f32_16x16x32_bf16 v[32:35], v[100:103], v[20:23], v[32:35]
s_cmp_ge_u32 s41, 28
s_cbranch_scc1 L_t67
s_waitcnt vmcnt(5)
s_cmp_ge_u32 s41, 24
s_cbranch_scc1 L_t67
s_waitcnt vmcnt(4)
s_cmp_ge_u32 s41, 20
s_cbranch_scc1 L_t67
s_waitcnt vmcnt(3)
L_t67:
buffer_load_dwordx4 v[128:131], v1, s[36:39], s50 offen offset:0 nt
s_waitcnt vmcnt(6)
v_mfma_f32_16x16x32_bf16 v[32:35], v[104:107], v[24:27], v[32:35]
s_cmp_ge_u32 s41, 27
s_cbranch_scc1 L_t68
s_waitcnt vmcnt(5)
s_cmp_ge_u32 s41, 23
s_cbranch_scc1 L_t68
s_waitcnt vmcnt(4)
s_cmp_ge_u32 s41, 19
s_cbranch_scc1 L_t68
s_waitcnt vmcnt(3)
L_t68:
buffer_load_dwordx4 v[132:135], v1, s[36:39], s50 offen offset:1024 nt
s_waitcnt lgkmcnt(0)
v_readfirstlane_b32 s41, v11
s_waitcnt vmcnt(6)
v_mfma_f32_16x16x32_bf16 v[32:35], v[108:111], v[28:31], v[32:35]
s_cmp_ge_u32 s41, 26
s_cbranch_scc1 L_t69
s_waitcnt vmcnt(5)
s_cmp_ge_u32 s41, 22
s_cbranch_scc1 L_t69
s_waitcnt vmcnt(4)
s_cmp_ge_u32 s41, 18
s_cbranch_scc1 L_t69
s_waitcnt vmcnt(3)
L_t69:
buffer_load_dwordx4 v[136:139], v1, s[36:39], s50 offen offset:2048 nt
v_mov_b32_dpp v79, v36 quad_perm:[0,0,0,0] row_mask:0xf bank_mask:0xf
v_mov_b32_dpp v55, v38 quad_perm:[2,2,2,2] row_mask:0xf bank_mask:0xf
s_nop 0
v_add_f32_dpp v79, v37, v79 quad_perm:[1,1,1,1] row_mask:0xf bank_mask:0xf
v_add_f32_dpp v55, v39, v55 quad_perm:[3,3,3,3] row_mask:0xf bank_mask:0xf
v_add_f32 v79, v79, v55
v_cvt_pk_bf16_f32 v56, v78, v79
v_lshlrev_b32 v78, 16, v56
v_and_b32 v79, 0xffff0000, v56
v_mul_f32 v78, s60, v78
v_mul_f32 v79, s60, v79
v_cvt_pk_bf16_f32 v56, v78, v79
v_lshlrev_b32 v78, 16, v56
v_and_b32 v79, 0xffff0000, v56
v_max3_f32 v52, v52, v78, v79
s_waitcnt vmcnt(6)
v_mfma_f32_16x16x32_bf16 v[36:39], v[112:115], v[16:19], 0
s_cmp_ge_u32 s41, 25
s_cbranch_scc1 L_t70
s_waitcnt vmcnt(5)
s_cmp_ge_u32 s41, 21
s_cbranch_scc1 L_t70
s_waitcnt vmcnt(4)
s_cmp_ge_u32 s41, 17
s_cbranch_scc1 L_t70
s_waitcnt vmcnt(3)
L_t70:
buffer_load_dwordx4 v[140:143], v1, s[36:39], s50 offen offset:3072 nt
s_add_u32 s50, s50, 131072
s_and_b32 s50, s50, 0x3fffff
s_waitcnt vmcnt(6)
v_mfma_f32_16x16x32_bf16 v[36:39], v[116:119], v[20:23], v[36:39]
s_cmp_ge_u32 s41, 28
s_cbranch_scc1 L_t71
s_waitcnt vmcnt(5)
s_cmp_ge_u32 s41, 24
s_cbranch_scc1 L_t71
s_waitcnt vmcnt(4)
s_cmp_ge_u32 s41, 20
s_cbranch_scc1 L_t71
s_waitcnt vmcnt(3)
L_t71:
buffer_load_dwordx4 v[144:147], v1, s[36:39], s50 offen offset:0 nt
s_waitcnt vmcnt(6)
v_mfma_f32_16x16x32_bf16 v[36:39], v[120:123], v[24:27], v[36:39]
s_cmp_ge_u32 s41, 27
s_cbranch_scc1 L_t72
s_waitcnt vmcnt(5)
s_cmp_ge_u32 s41, 23
s_cbranch_scc1 L_t72
s_waitcnt vmcnt(4)
s_cmp_ge_u32 s41, 19
s_cbranch_scc1 L_t72
s_waitcnt vmcnt(3)
L_t72:
buffer_load_dwordx4 v[148:151], v1, s[36:39], s50 offen offset:1024 nt
s_waitcnt vmcnt(6)
v_mfma_f32_16x16x32_bf16 v[36:39], v[124:127], v[28:31], v[36:39]
s_cmp_ge_u32 s41, 26
s_cbranch_scc1 L_t73
s_waitcnt vmcnt(5)
s_cmp_ge_u32 s41, 22
s_cbranch_scc1 L_t73
s_waitcnt vmcnt(4)
s_cmp_ge_u32 s41, 18
s_cbranch_scc1 L_t73
s_waitcnt vmcnt(3)
L_t73:
buffer_load_dwordx4 v[152:155], v1, s[36:39], s50 offen offset:2048 nt
v_mov_b32_dpp v80, v32 quad_perm:[0,0,0,0] row_mask:0xf bank_mask:0xf
v_mov_b32_dpp v55, v34 quad_perm:[2,2,2,2] row_mask:0xf bank_mask:0xf
s_nop 0
v_add_f32_dpp v80, v33, v80 quad_perm:[1,1,1,1] row_mask:0xf bank_mask:0xf
v_add_f32_dpp v55, v35, v55 quad_perm:[3,3,3,3] row_mask:0xf bank_mask:0xf
v_add_f32 v80, v80, v55
s_waitcnt vmcnt(6)
v_mfma_f32_16x16x32_bf16 v[32:35], v[128:131], v[16:19], 0
s_cmp_ge_u32 s41, 25
s_cbranch_scc1 L_t74
s_waitcnt vmcnt(5)
s_cmp_ge_u32 s41, 21
s_cbranch_scc1 L_t74
s_waitcnt vmcnt(4)
s_cmp_ge_u32 s41, 17
s_cbranch_scc1 L_t74
s_waitcnt vmcnt(3)
L_t74:
buffer_load_dwordx4 v[156:159], v1, s[36:39], s50 offen offset:3072 nt
s_add_u32 s50, s50, 131072
s_and_b32 s50, s50, 0x3fffff
v_mov_b32 v56, 3
ds_write_b32 v3, v56 offset:640
ds_read_b32 v11, v8 offset:672
s_waitcnt vmcnt(6)
v_mfma_f32_16x16x32_bf16 v[32:35], v[132:135], v[20:23], v[32:35]
s_cmp_ge_u32 s41, 28
s_cbranch_scc1 L_t75
s_waitcnt vmcnt(5)
s_cmp_ge_u32 s41, 24
s_cbranch_scc1 L_t75
s_waitcnt vmcnt(4)
s_cmp_ge_u32 s41, 20
s_cbranch_scc1 L_t75
s_waitcnt vmcnt(3)
L_t75:
buffer_load_dwordx4 v[160:163], v1, s[36:39], s50 offen offset:0 nt
s_waitcnt vmcnt(6)
v_mfma_f32_16x16x32_bf16 v[32:35], v[136:139], v[24:27], v[32:35]
s_cmp_ge_u32 s41, 27
s_cbranch_scc1 L_t76
s_waitcnt vmcnt(5)
s_cmp_ge_u32 s41, 23
s_cbranch_scc1 L_t76
s_waitcnt vmcnt(4)
s_cmp_ge_u32 s41, 19
s_cbranch_scc1 L_t76
s_waitcnt vmcnt(3)
L_t76:
buffer_load_dwordx4 v[164:167], v1, s[36:39], s50 offen offset:1024 nt
s_waitcnt lgkmcnt(0)
v_readfirstlane_b32 s41, v11
s_waitcnt vmcnt(6)
v_mfma_f32_16x16x32_bf16 v[32:35], v[140:143], v[28:31], v[32:35]
s_cmp_ge_u32 s41, 26
s_cbranch_scc1 L_t77
s_waitcnt vmcnt(5)
s_cmp_ge_u32 s41, 22
s_cbranch_scc1 L_t77
s_waitcnt vmcnt(4)
s_cmp_ge_u32 s41, 18
s_cbranch_scc1 L_t77
s_waitcnt vmcnt(3)
L_t77:
buffer_load_dwordx4 v[168:171], v1, s[36:39], s50 offen offset:2048 nt
v_mov_b32_dpp v81, v36 quad_perm:[0,0,0,0] row_mask:0xf bank_mask:0xf
v_mov_b32_dpp v55, v38 quad_perm:[2,2,2,2] row_mask:0xf bank_mask:0xf
s_nop 0
v_add_f32_dpp v81, v37, v81 quad_perm:[1,1,1,1] row_mask:0xf bank_mask:0xf
v_add_f32_dpp v55, v39, v55 quad_perm:[3,3,3,3] row_mask:0xf bank_mask:0xf
v_add_f32 v81, v81, v55
v_cvt_pk_bf16_f32 v56, v80, v81
v_lshlrev_b32 v80, 16, v56
v_and_b32 v81, 0xffff0000, v56
v_mul_f32 v80, s60, v80
v_mul_f32 v81, s60, v81
v_cvt_pk_bf16_f32 v56, v80, v81
v_lshlrev_b32 v80, 16, v56
v_and_b32 v81, 0xffff0000, v56
v_max3_f32 v52, v52, v80, v81
s_waitcnt vmcnt(6)
v_mfma_f32_16x16x32_bf16 v[36:39], v[144:147], v[16:19], 0
s_cmp_ge_u32 s41, 25
s_cbranch_scc1 L_t78
s_waitcnt vmcnt(5)
s_cmp_ge_u32 s41, 21
s_cbranch_scc1 L_t78
s_waitcnt vmcnt(4)
s_cmp_ge_u32 s41, 17
s_cbranch_scc1 L_t78
s_waitcnt vmcnt(3)
L_t78:
buffer_load_dwordx4 v[172:175], v1, s[36:39], s50 offen offset:3072 nt
s_add_u32 s50, s50, 131072
s_and_b32 s50, s50, 0x3fffff
s_waitcnt vmcnt(6)
v_mfma_f32_16x16x32_bf16 v[36:39], v[148:151], v[20:23], v[36:39]
s_cmp_ge_u32 s41, 28
s_cbranch_scc1 L_t79
s_waitcnt vmcnt(5)
s_cmp_ge_u32 s41, 24
s_cbranch_scc1 L_t79
s_waitcnt vmcnt(4)
s_cmp_ge_u32 s41, 20
s_cbranch_scc1 L_t79
s_waitcnt vmcnt(3)
L_t79:
buffer_load_dwordx4 v[176:179], v1, s[36:39], s50 offen offset:0 nt
s_waitcnt vmcnt(6)
v_mfma_f32_16x16x32_bf16 v[36:39], v[152:155], v[24:27], v[36:39]
s_cmp_ge_u32 s41, 27
s_cbranch_scc1 L_t80
s_waitcnt vmcnt(5)
s_cmp_ge_u32 s41, 23
s_cbranch_scc1 L_t80
s_waitcnt vmcnt(4)
s_cmp_ge_u32 s41, 19
s_cbranch_scc1 L_t80
s_waitcnt vmcnt(3)
L_t80:
buffer_load_dwordx4 v[180:183], v1, s[36:39], s50 offen offset:1024 nt
s_waitcnt vmcnt(6)
v_mfma_f32_16x16x32_bf16 v[36:39], v[156:159], v[28:31], v[36:39]
s_cmp_ge_u32 s41, 26
s_cbranch_scc1 L_t81
s_waitcnt vmcnt(5)
s_cmp_ge_u32 s41, 22
s_cbranch_scc1 L_t81
s_waitcnt vmcnt(4)
s_cmp_ge_u32 s41, 18
s_cbranch_scc1 L_t81
s_waitcnt vmcnt(3)
L_t81:
buffer_load_dwordx4 v[184:187], v1, s[36:39], s50 offen offset:2048 nt
v_mov_b32_dpp v82, v32 quad_perm:[0,0,0,0] row_mask:0xf bank_mask:0xf
v_mov_b32_dpp v55, v34 quad_perm:[2,2,2,2] row_mask:0xf bank_mask:0xf
s_nop 0
v_add_f32_dpp v82, v33, v82 quad_perm:[1,1,1,1] row_mask:0xf bank_mask:0xf
v_add_f32_dpp v55, v35, v55 quad_perm:[3,3,3,3] row_mask:0xf bank_mask:0xf
v_add_f32 v82, v82, v55
s_waitcnt vmcnt(6)
v_mfma_f32_16x16x32_bf16 v[32:35], v[160:163], v[16:19], 0
s_cmp_ge_u32 s41, 25
s_cbranch_scc1 L_t82
s_waitcnt vmcnt(5)
s_cmp_ge_u32 s41, 21
s_cbranch_scc1 L_t82
s_waitcnt vmcnt(4)
s_cmp_ge_u32 s41, 17
s_cbranch_scc1 L_t82
s_waitcnt vmcnt(3)
L_t82:
buffer_load_dwordx4 v[188:191], v1, s[36:39], s50 offen offset:3072 nt
s_add_u32 s50, s50, 131072
s_and_b32 s50, s50, 0x3fffff
ds_read_b32 v11, v8 offset:672
s_waitcnt vmcnt(6)
v_mfma_f32_16x16x32_bf16 v[32:35], v[164:167], v[20:23], v[32:35]
s_cmp_ge_u32 s41, 28
s_cbranch_scc1 L_t83
s_waitcnt vmcnt(5)
s_cmp_ge_u32 s41, 24
s_cbranch_scc1 L_t83
s_waitcnt vmcnt(4)
s_cmp_ge_u32 s41, 20
s_cbranch_scc1 L_t83
s_waitcnt vmcnt(3)
L_t83:
buffer_load_dwordx4 v[192:195], v1, s[36:39], s50 offen offset:0 nt
s_waitcnt vmcnt(6)
v_mfma_f32_16x16x32_bf16 v[32:35], v[168:171], v[24:27], v[32:35]
s_cmp_ge_u32 s41, 27
s_cbranch_scc1 L_t84
s_waitcnt vmcnt(5)
s_cmp_ge_u32 s41, 23
s_cbranch_scc1 L_t84
s_waitcnt vmcnt(4)
s_cmp_ge_u32 s41, 19
s_cbranch_scc1 L_t84
s_waitcnt vmcnt(3)
L_t84:
buffer_load_dwordx4 v[196:199], v1, s[36:39], s50 offen offset:1024 nt
s_waitcnt lgkmcnt(0)
v_readfirstlane_b32 s41, v11
s_waitcnt vmcnt(6)
v_mfma_f32_16x16x32_bf16 v[32:35], v[172:175], v[28:31], v[32:35]
s_cmp_ge_u32 s41, 26
s_cbranch_scc1 L_t85
s_waitcnt vmcnt(5)
s_cmp_ge_u32 s41, 22
s_cbranch_scc1 L_t85
s_waitcnt vmcnt(4)
s_cmp_ge_u32 s41, 18
s_cbranch_scc1 L_t85
s_waitcnt vmcnt(3)
L_t85:
buffer_load_dwordx4 v[200:203], v1, s[36:39], s50 offen offset:2048 nt
v_mov_b32_dpp v83, v36 quad_perm:[0,0,0,0] row_mask:0xf bank_mask:0xf
v_mov_b32_dpp v55, v38 quad_perm:[2,2,2,2] row_mask:0xf bank_mask:0xf
s_nop 0
v_add_f32_dpp v83, v37, v83 quad_perm:[1,1,1,1] row_mask:0xf bank_mask:0xf
v_add_f32_dpp v55, v39, v55 quad_perm:[3,3,3,3] row_mask:0xf bank_mask:0xf
v_add_f32 v83, v83, v55
v_cvt_pk_bf16_f32 v56, v82, v83
v_lshlrev_b32 v82, 16, v56
v_and_b32 v83, 0xffff0000, v56
v_mul_f32 v82, s60, v82
v_mul_f32 v83, s60, v83
v_cvt_pk_bf16_f32 v56, v82, v83
v_lshlrev_b32 v82, 16, v56
v_and_b32 v83, 0xffff0000, v56
v_max3_f32 v52, v52, v82, v83
s_waitcnt vmcnt(6)
v_mfma_f32_16x16x32_bf16 v[36:39], v[176:179], v[16:19], 0
s_cmp_ge_u32 s41, 25
s_cbranch_scc1 L_t86
s_waitcnt vmcnt(5)
s_cmp_ge_u32 s41, 21
s_cbranch_scc1 L_t86
s_waitcnt vmcnt(4)
s_cmp_ge_u32 s41, 17
s_cbranch_scc1 L_t86
s_waitcnt vmcnt(3)
L_t86:
buffer_load_dwordx4 v[204:207], v1, s[36:39], s50 offen offset:3072 nt
s_add_u32 s50, s50, 131072
s_and_b32 s50, s50, 0x3fffff
s_waitcnt vmcnt(6)
v_mfma_f32_16x16x32_bf16 v[36:39], v[180:183], v[20:23], v[36:39]
s_cmp_ge_u32 s41, 28
s_cbranch_scc1 L_t87
s_waitcnt vmcnt(5)
s_cmp_ge_u32 s41, 24
s_cbranch_scc1 L_t87
s_waitcnt vmcnt(4)
s_cmp_ge_u32 s41, 20
s_cbranch_scc1 L_t87
s_waitcnt vmcnt(3)
L_t87:
buffer_load_dwordx4 v[208:211], v1, s[36:39], s50 offen offset:0 nt
s_waitcnt vmcnt(6)
v_mfma_f32_16x16x32_bf16 v[36:39], v[184:187], v[24:27], v[36:39]
s_cmp_ge_u32 s41, 27
s_cbranch_scc1 L_t88
s_waitcnt vmcnt(5)
s_cmp_ge_u32 s41, 23
s_cbranch_scc1 L_t88
s_waitcnt vmcnt(4)
s_cmp_ge_u32 s41, 19
s_cbranch_scc1 L_t88
s_waitcnt vmcnt(3)
L_t88:
buffer_load_dwordx4 v[212:215], v1, s[36:39], s50 offen offset:1024 nt
s_waitcnt vmcnt(6)
v_mfma_f32_16x16x32_bf16 v[36:39], v[188:191], v[28:31], v[36:39]
s_cmp_ge_u32 s41, 26
s_cbranch_scc1 L_t89
s_waitcnt vmcnt(5)
s_cmp_ge_u32 s41, 22
s_cbranch_scc1 L_t89
s_waitcnt vmcnt(4)
s_cmp_ge_u32 s41, 18
s_cbranch_scc1 L_t89
s_waitcnt vmcnt(3)
L_t89:
buffer_load_dwordx4 v[216:219], v1, s[36:39], s50 offen offset:2048 nt
v_mov_b32_dpp v84, v32 quad_perm:[0,0,0,0] row_mask:0xf bank_mask:0xf
v_mov_b32_dpp v55, v34 quad_perm:[2,2,2,2] row_mask:0xf bank_mask:0xf
s_nop 0
v_add_f32_dpp v84, v33, v84 quad_perm:[1,1,1,1] row_mask:0xf bank_mask:0xf
v_add_f32_dpp v55, v35, v55 quad_perm:[3,3,3,3] row_mask:0xf bank_mask:0xf
v_add_f32 v84, v84, v55
s_waitcnt vmcnt(6)
v_mfma_f32_16x16x32_bf16 v[32:35], v[192:195], v[16:19], 0
s_cmp_ge_u32 s41, 25
s_cbranch_scc1 L_t90
s_waitcnt vmcnt(5)
s_cmp_ge_u32 s41, 21
s_cbranch_scc1 L_t90
s_waitcnt vmcnt(4)
s_cmp_ge_u32 s41, 17
s_cbranch_scc1 L_t90
s_waitcnt vmcnt(3)
L_t90:
buffer_load_dwordx4 v[220:223], v1, s[36:39], s50 offen offset:3072 nt
s_add_u32 s50, s50, 131072
s_and_b32 s50, s50, 0x3fffff
v_mov_b32 v56, 4
ds_write_b32 v3, v56 offset:640
ds_read_b32 v11, v8 offset:672
s_waitcnt vmcnt(6)
v_mfma_f32_16x16x32_bf16 v[32:35], v[196:199], v[20:23], v[32:35]
s_cmp_ge_u32 s41, 28
s_cbranch_scc1 L_t91
s_waitcnt vmcnt(5)
s_cmp_ge_u32 s41, 24
s_cbranch_scc1 L_t91
s_waitcnt vmcnt(4)
s_cmp_ge_u32 s41, 20
s_cbranch_scc1 L_t91
s_waitcnt vmcnt(3)
L_t91:
buffer_load_dwordx4 v[224:227], v1, s[36:39], s50 offen offset:0 nt
s_waitcnt vmcnt(6)
v_mfma_f32_16x16x32_bf16 v[32:35], v[200:203], v[24:27], v[32:35]
s_cmp_ge_u32 s41, 27
s_cbranch_scc1 L_t92
s_waitcnt vmcnt(5)
s_cmp_ge_u32 s41, 23
s_cbranch_scc1 L_t92
s_waitcnt vmcnt(4)
s_cmp_ge_u32 s41, 19
s_cbranch_scc1 L_t92
s_waitcnt vmcnt(3)
L_t92:
buffer_load_dwordx4 v[228:231], v1, s[36:39], s50 offen offset:1024 nt
s_waitcnt lgkmcnt(0)
v_readfirstlane_b32 s41, v11
s_waitcnt vmcnt(6)
v_mfma_f32_16x16x32_bf16 v[32:35], v[204:207], v[28:31], v[32:35]
s_cmp_ge_u32 s41, 26
s_cbranch_scc1 L_t93
s_waitcnt vmcnt(5)
s_cmp_ge_u32 s41, 22
s_cbranch_scc1 L_t93
s_waitcnt vmcnt(4)
s_cmp_ge_u32 s41, 18
s_cbranch_scc1 L_t93
s_waitcnt vmcnt(3)
L_t93:
buffer_load_dwordx4 v[232:235], v1, s[36:39], s50 offen offset:2048 nt
v_mov_b32_dpp v85, v36 quad_perm:[0,0,0,0] row_mask:0xf bank_mask:0xf
v_mov_b32_dpp v55, v38 quad_perm:[2,2,2,2] row_mask:0xf bank_mask:0xf
s_nop 0
v_add_f32_dpp v85, v37, v85 quad_perm:[1,1,1,1] row_mask:0xf bank_mask:0xf
v_add_f32_dpp v55, v39, v55 quad_perm:[3,3,3,3] row_mask:0xf bank_mask:0xf
v_add_f32 v85, v85, v55
v_cvt_pk_bf16_f32 v56, v84, v85
v_lshlrev_b32 v84, 16, v56
v_and_b32 v85, 0xffff0000, v56
v_mul_f32 v84, s60, v84
v_mul_f32 v85, s60, v85
v_cvt_pk_bf16_f32 v56, v84, v85
v_lshlrev_b32 v84, 16, v56
v_and_b32 v85, 0xffff0000, v56
v_max3_f32 v52, v52, v84, v85
s_waitcnt vmcnt(6)
v_mfma_f32_16x16x32_bf16 v[36:39], v[208:211], v[16:19], 0
s_cmp_ge_u32 s41, 25
s_cbranch_scc1 L_t94
s_waitcnt vmcnt(5)
s_cmp_ge_u32 s41, 21
s_cbranch_scc1 L_t94
s_waitcnt vmcnt(4)
s_cmp_ge_u32 s41, 17
s_cbranch_scc1 L_t94
s_waitcnt vmcnt(3)
L_t94:
buffer_load_dwordx4 v[236:239], v1, s[36:39], s50 offen offset:3072 nt
s_add_u32 s50, s50, 131072
s_and_b32 s50, s50, 0x3fffff
s_waitcnt vmcnt(6)
v_mfma_f32_16x16x32_bf16 v[36:39], v[212:215], v[20:23], v[36:39]
s_cmp_ge_u32 s41, 28
s_cbranch_scc1 L_t95
s_waitcnt vmcnt(5)
s_cmp_ge_u32 s41, 24
s_cbranch_scc1 L_t95
s_waitcnt vmcnt(4)
s_cmp_ge_u32 s41, 20
s_cbranch_scc1 L_t95
s_waitcnt vmcnt(3)
L_t95:
buffer_load_dwordx4 v[240:243], v1, s[36:39], s50 offen offset:0 nt
s_waitcnt vmcnt(6)
v_mfma_f32_16x16x32_bf16 v[36:39], v[216:219], v[24:27], v[36:39]
s_cmp_ge_u32 s41, 27
s_cbranch_scc1 L_t96
s_waitcnt vmcnt(5)
s_cmp_ge_u32 s41, 23
s_cbranch_scc1 L_t96
s_waitcnt vmcnt(4)
s_cmp_ge_u32 s41, 19
s_cbranch_scc1 L_t96
s_waitcnt vmcnt(3)
L_t96:
buffer_load_dwordx4 v[244:247], v1, s[36:39], s50 offen offset:1024 nt
s_waitcnt vmcnt(6)
v_mfma_f32_16x16x32_bf16 v[36:39], v[220:223], v[28:31], v[36:39]
s_cmp_ge_u32 s41, 26
s_cbranch_scc1 L_t97
s_waitcnt vmcnt(5)
s_cmp_ge_u32 s41, 22
s_cbranch_scc1 L_t97
s_waitcnt vmcnt(4)
s_cmp_ge_u32 s41, 18
s_cbranch_scc1 L_t97
s_waitcnt vmcnt(3)
L_t97:
buffer_load_dwordx4 v[248:251], v1, s[36:39], s50 offen offset:2048 nt
v_mov_b32_dpp v86, v32 quad_perm:[0,0,0,0] row_mask:0xf bank_mask:0xf
v_mov_b32_dpp v55, v34 quad_perm:[2,2,2,2] row_mask:0xf bank_mask:0xf
s_nop 0
v_add_f32_dpp v86, v33, v86 quad_perm:[1,1,1,1] row_mask:0xf bank_mask:0xf
v_add_f32_dpp v55, v35, v55 quad_perm:[3,3,3,3] row_mask:0xf bank_mask:0xf
v_add_f32 v86, v86, v55
s_waitcnt vmcnt(6)
v_mfma_f32_16x16x32_bf16 v[32:35], v[224:227], v[16:19], 0
s_cmp_ge_u32 s41, 25
s_cbranch_scc1 L_t98
s_waitcnt vmcnt(5)
s_cmp_ge_u32 s41, 21
s_cbranch_scc1 L_t98
s_waitcnt vmcnt(4)
s_cmp_ge_u32 s41, 17
s_cbranch_scc1 L_t98
s_waitcnt vmcnt(3)
L_t98:
buffer_load_dwordx4 v[252:255], v1, s[36:39], s50 offen offset:3072 nt
s_add_u32 s50, s50, 131072
s_and_b32 s50, s50, 0x3fffff
ds_read_b32 v11, v8 offset:672
s_waitcnt vmcnt(6)
v_mfma_f32_16x16x32_bf16 v[32:35], v[228:231], v[20:23], v[32:35]
s_cmp_ge_u32 s41, 28
s_cbranch_scc1 L_t99
s_waitcnt vmcnt(5)
s_cmp_ge_u32 s41, 24
s_cbranch_scc1 L_t99
s_waitcnt vmcnt(4)
s_cmp_ge_u32 s41, 20
s_cbranch_scc1 L_t99
s_waitcnt vmcnt(3)
L_t99:
buffer_load_dwordx4 v[96:99], v1, s[36:39], s50 offen offset:0 nt
s_waitcnt vmcnt(6)
v_mfma_f32_16x16x32_bf16 v[32:35], v[232:235], v[24:27], v[32:35]
s_cmp_ge_u32 s41, 27
s_cbranch_scc1 L_t100
s_waitcnt vmcnt(5)
s_cmp_ge_u32 s41, 23
s_cbranch_scc1 L_t100
s_waitcnt vmcnt(4)
s_cmp_ge_u32 s41, 19
s_cbranch_scc1 L_t100
s_waitcnt vmcnt(3)
L_t100:
buffer_load_dwordx4 v[100:103], v1, s[36:39], s50 offen offset:1024 nt
s_waitcnt lgkmcnt(0)
v_readfirstlane_b32 s41, v11
s_waitcnt vmcnt(6)
v_mfma_f32_16x16x32_bf16 v[32:35], v[236:239], v[28:31], v[32:35]
s_cmp_ge_u32 s41, 26
s_cbranch_scc1 L_t101
s_waitcnt vmcnt(5)
s_cmp_ge_u32 s41, 22
s_cbranch_scc1 L_t101
s_waitcnt vmcnt(4)
s_cmp_ge_u32 s41, 18
s_cbranch_scc1 L_t101
s_waitcnt vmcnt(3)
L_t101:
buffer_load_dwordx4 v[104:107], v1, s[36:39], s50 offen offset:2048 nt
v_mov_b32_dpp v87, v36 quad_perm:[0,0,0,0] row_mask:0xf bank_mask:0xf
v_mov_b32_dpp v55, v38 quad_perm:[2,2,2,2] row_mask:0xf bank_mask:0xf
s_nop 0
v_add_f32_dpp v87, v37, v87 quad_perm:[1,1,1,1] row_mask:0xf bank_mask:0xf
v_add_f32_dpp v55, v39, v55 quad_perm:[3,3,3,3] row_mask:0xf bank_mask:0xf
v_add_f32 v87, v87, v55
v_cvt_pk_bf16_f32 v56, v86, v87
v_lshlrev_b32 v86, 16, v56
v_and_b32 v87, 0xffff0000, v56
v_mul_f32 v86, s60, v86
v_mul_f32 v87, s60, v87
v_cvt_pk_bf16_f32 v56, v86, v87
v_lshlrev_b32 v86, 16, v56
v_and_b32 v87, 0xffff0000, v56
v_max3_f32 v52, v52, v86, v87
s_waitcnt vmcnt(6)
v_mfma_f32_16x16x32_bf16 v[36:39], v[240:243], v[16:19], 0
s_cmp_ge_u32 s41, 25
s_cbranch_scc1 L_t102
s_waitcnt vmcnt(5)
s_cmp_ge_u32 s41, 21
s_cbranch_scc1 L_t102
s_waitcnt vmcnt(4)
s_cmp_ge_u32 s41, 17
s_cbranch_scc1 L_t102
s_waitcnt vmcnt(3)
L_t102:
buffer_load_dwordx4 v[108:111], v1, s[36:39], s50 offen offset:3072 nt
s_add_u32 s50, s50, 131072
s_and_b32 s50, s50, 0x3fffff
s_waitcnt vmcnt(6)
v_mfma_f32_16x16x32_bf16 v[36:39], v[244:247], v[20:23], v[36:39]
s_cmp_ge_u32 s41, 28
s_cbranch_scc1 L_t103
s_waitcnt vmcnt(5)
s_cmp_ge_u32 s41, 24
s_cbranch_scc1 L_t103
s_waitcnt vmcnt(4)
s_cmp_ge_u32 s41, 20
s_cbranch_scc1 L_t103
s_waitcnt vmcnt(3)
L_t103:
buffer_load_dwordx4 v[112:115], v1, s[36:39], s50 offen offset:0 nt
s_waitcnt vmcnt(6)
v_mfma_f32_16x16x32_bf16 v[36:39], v[248:251], v[24:27], v[36:39]
s_cmp_ge_u32 s41, 27
s_cbranch_scc1 L_t104
s_waitcnt vmcnt(5)
s_cmp_ge_u32 s41, 23
s_cbranch_scc1 L_t104
s_waitcnt vmcnt(4)
s_cmp_ge_u32 s41, 19
s_cbranch_scc1 L_t104
s_waitcnt vmcnt(3)
L_t104:
buffer_load_dwordx4 v[116:119], v1, s[36:39], s50 offen offset:1024 nt
s_waitcnt vmcnt(6)
v_mfma_f32_16x16x32_bf16 v[36:39], v[252:255], v[28:31], v[36:39]
s_cmp_ge_u32 s41, 26
s_cbranch_scc1 L_t105
s_waitcnt vmcnt(5)
s_cmp_ge_u32 s41, 22
s_cbranch_scc1 L_t105
s_waitcnt vmcnt(4)
s_cmp_ge_u32 s41, 18
s_cbranch_scc1 L_t105
s_waitcnt vmcnt(3)
L_t105:
buffer_load_dwordx4 v[120:123], v1, s[36:39], s50 offen offset:2048 nt
v_mov_b32_dpp v88, v32 quad_perm:[0,0,0,0] row_mask:0xf bank_mask:0xf
v_mov_b32_dpp v55, v34 quad_perm:[2,2,2,2] row_mask:0xf bank_mask:0xf
s_nop 0
v_add_f32_dpp v88, v33, v88 quad_perm:[1,1,1,1] row_mask:0xf bank_mask:0xf
v_add_f32_dpp v55, v35, v55 quad_perm:[3,3,3,3] row_mask:0xf bank_mask:0xf
v_add_f32 v88, v88, v55
s_waitcnt vmcnt(6)
v_mfma_f32_16x16x32_bf16 v[32:35], v[96:99], v[16:19], 0
s_cmp_ge_u32 s41, 25
s_cbranch_scc1 L_t106
s_waitcnt vmcnt(5)
s_cmp_ge_u32 s41, 21
s_cbranch_scc1 L_t106
s_waitcnt vmcnt(4)
s_cmp_ge_u32 s41, 17
s_cbranch_scc1 L_t106
s_waitcnt vmcnt(3)
L_t106:
buffer_load_dwordx4 v[124:127], v1, s[36:39], s50 offen offset:3072 nt
s_add_u32 s50, s50, 131072
s_and_b32 s50, s50, 0x3fffff
v_mov_b32 v56, 5
ds_write_b32 v3, v56 offset:640
ds_read_b32 v11, v8 offset:672
s_waitcnt vmcnt(6)
v_mfma_f32_16x16x32_bf16 v[32:35], v[100:103], v[20:23], v[32:35]
s_cmp_ge_u32 s41, 28
s_cbranch_scc1 L_t107
s_waitcnt vmcnt(5)
s_cmp_ge_u32 s41, 24
s_cbranch_scc1 L_t107
s_waitcnt vmcnt(4)
s_cmp_ge_u32 s41, 20
s_cbranch_scc1 L_t107
s_waitcnt vmcnt(3)
L_t107:
buffer_load_dwordx4 v[128:131], v2, s[44:47], s50 offen offset:0 nt
s_waitcnt vmcnt(6)
v_mfma_f32_16x16x32_bf16 v[32:35], v[104:107], v[24:27], v[32:35]
s_cmp_ge_u32 s41, 27
s_cbranch_scc1 L_t108
s_waitcnt vmcnt(5)
s_cmp_ge_u32 s41, 23
s_cbranch_scc1 L_t108
s_waitcnt vmcnt(4)
s_cmp_ge_u32 s41, 19
s_cbranch_scc1 L_t108
s_waitcnt vmcnt(3)
L_t108:
buffer_load_dwordx4 v[132:135], v2, s[44:47], s50 offen offset:1024 nt
s_waitcnt lgkmcnt(0)
v_readfirstlane_b32 s41, v11
s_waitcnt vmcnt(6)
v_mfma_f32_16x16x32_bf16 v[32:35], v[108:111], v[28:31], v[32:35]
s_cmp_ge_u32 s41, 26
s_cbranch_scc1 L_t109
s_waitcnt vmcnt(5)
s_cmp_ge_u32 s41, 22
s_cbranch_scc1 L_t109
s_waitcnt vmcnt(4)
s_cmp_ge_u32 s41, 18
s_cbranch_scc1 L_t109
s_waitcnt vmcnt(3)
L_t109:
buffer_load_dwordx4 v[136:139], v2, s[44:47], s50 offen offset:2048 nt
v_mov_b32_dpp v89, v36 quad_perm:[0,0,0,0] row_mask:0xf bank_mask:0xf
v_mov_b32_dpp v55, v38 quad_perm:[2,2,2,2] row_mask:0xf bank_mask:0xf
s_nop 0
v_add_f32_dpp v89, v37, v89 quad_perm:[1,1,1,1] row_mask:0xf bank_mask:0xf
v_add_f32_dpp v55, v39, v55 quad_perm:[3,3,3,3] row_mask:0xf bank_mask:0xf
v_add_f32 v89, v89, v55
v_cvt_pk_bf16_f32 v56, v88, v89
v_lshlrev_b32 v88, 16, v56
v_and_b32 v89, 0xffff0000, v56
v_mul_f32 v88, s60, v88
v_mul_f32 v89, s60, v89
v_cvt_pk_bf16_f32 v56, v88, v89
v_lshlrev_b32 v88, 16, v56
v_and_b32 v89, 0xffff0000, v56
v_max3_f32 v52, v52, v88, v89
s_waitcnt vmcnt(6)
v_mfma_f32_16x16x32_bf16 v[36:39], v[112:115], v[16:19], 0
s_cmp_ge_u32 s41, 25
s_cbranch_scc1 L_t110
s_waitcnt vmcnt(5)
s_cmp_ge_u32 s41, 21
s_cbranch_scc1 L_t110
s_waitcnt vmcnt(4)
s_cmp_ge_u32 s41, 17
s_cbranch_scc1 L_t110
s_waitcnt vmcnt(3)
L_t110:
buffer_load_dwordx4 v[140:143], v2, s[44:47], s50 offen offset:3072 nt
s_add_u32 s50, s50, 131072
s_and_b32 s50, s50, 0x3fffff
s_waitcnt vmcnt(6)
v_mfma_f32_16x16x32_bf16 v[36:39], v[116:119], v[20:23], v[36:39]
s_cmp_ge_u32 s41, 28
s_cbranch_scc1 L_t111
s_waitcnt vmcnt(5)
s_cmp_ge_u32 s41, 24
s_cbranch_scc1 L_t111
s_waitcnt vmcnt(4)
s_cmp_ge_u32 s41, 20
s_cbranch_scc1 L_t111
s_waitcnt vmcnt(3)
L_t111:
buffer_load_dwordx4 v[144:147], v2, s[44:47], s50 offen offset:0 nt
s_waitcnt vmcnt(6)
v_mfma_f32_16x16x32_bf16 v[36:39], v[120:123], v[24:27], v[36:39]
s_cmp_ge_u32 s41, 27
s_cbranch_scc1 L_t112
s_waitcnt vmcnt(5)
s_cmp_ge_u32 s41, 23
s_cbranch_scc1 L_t112
s_waitcnt vmcnt(4)
s_cmp_ge_u32 s41, 19
s_cbranch_scc1 L_t112
s_waitcnt vmcnt(3)
L_t112:
buffer_load_dwordx4 v[148:151], v2, s[44:47], s50 offen offset:1024 nt
s_waitcnt vmcnt(6)
v_mfma_f32_16x16x32_bf16 v[36:39], v[124:127], v[28:31], v[36:39]
s_cmp_ge_u32 s41, 26
s_cbranch_scc1 L_t113
s_waitcnt vmcnt(5)
s_cmp_ge_u32 s41, 22
s_cbranch_scc1 L_t113
s_waitcnt vmcnt(4)
s_cmp_ge_u32 s41, 18
s_cbranch_scc1 L_t113
s_waitcnt vmcnt(3)
L_t113:
buffer_load_dwordx4 v[152:155], v2, s[44:47], s50 offen offset:2048 nt
v_mov_b32_dpp v90, v32 quad_perm:[0,0,0,0] row_mask:0xf bank_mask:0xf
v_mov_b32_dpp v55, v34 quad_perm:[2,2,2,2] row_mask:0xf bank_mask:0xf
s_nop 0
v_add_f32_dpp v90, v33, v90 quad_perm:[1,1,1,1] row_mask:0xf bank_mask:0xf
v_add_f32_dpp v55, v35, v55 quad_perm:[3,3,3,3] row_mask:0xf bank_mask:0xf
v_add_f32 v90, v90, v55
s_nop 7
v_mov_b32_dpp v91, v36 quad_perm:[0,0,0,0] row_mask:0xf bank_mask:0xf
v_mov_b32_dpp v55, v38 quad_perm:[2,2,2,2] row_mask:0xf bank_mask:0xf
s_nop 0
v_add_f32_dpp v91, v37, v91 quad_perm:[1,1,1,1] row_mask:0xf bank_mask:0xf
v_add_f32_dpp v55, v39, v55 quad_perm:[3,3,3,3] row_mask:0xf bank_mask:0xf
v_add_f32 v91, v91, v55
v_cvt_pk_bf16_f32 v56, v90, v91
v_lshlrev_b32 v90, 16, v56
v_and_b32 v91, 0xffff0000, v56
v_mul_f32 v90, s60, v90
v_mul_f32 v91, s60, v91
v_cvt_pk_bf16_f32 v56, v90, v91
v_lshlrev_b32 v90, 16, v56
v_and_b32 v91, 0xffff0000, v56
v_max3_f32 v52, v52, v90, v91
s_nop 1
v_max_f32_dpp v52, v52, v52 row_ror:4 row_mask:0xf bank_mask:0xf
s_nop 1
v_max_f32_dpp v52, v52, v52 row_ror:8 row_mask:0xf bank_mask:0xf
s_nop 1
v_max_f32_dpp v52, v52, v52 row_bcast:15 row_mask:0xa bank_mask:0xf
s_nop 1
v_max_f32_dpp v52, v52, v52 row_bcast:31 row_mask:0xc bank_mask:0xf
s_nop 0
v_readlane_b32 s62, v52, 63
s_nop 1
v_mov_b32 v54, s62
v_mul_f32 v54, s61, v54
v_fma_f32 v60, v60, s61, -v54
v_fma_f32 v61, v61, s61, -v54
v_exp_f32 v60, v60
v_exp_f32 v61, v61
s_nop 0
v_add_f32 v53, v53, v60
v_cvt_pk_bf16_f32 v60, v60, v60
v_add_f32 v53, v53, v61
v_cvt_pk_bf16_f32 v61, v61, v61
s_nop 1
v_and_b32_dpp v44, v60, v12 row_newbcast:0 row_mask:0xf bank_mask:0xf
v_and_b32_dpp v45, v60, v13 row_newbcast:0 row_mask:0xf bank_mask:0xf
v_and_b32_dpp v46, v60, v14 row_newbcast:0 row_mask:0xf bank_mask:0xf
v_and_b32_dpp v47, v60, v15 row_newbcast:0 row_mask:0xf bank_mask:0xf
v_fma_f32 v62, v62, s61, -v54
v_fma_f32 v63, v63, s61, -v54
v_exp_f32 v62, v62
v_exp_f32 v63, v63
s_nop 0
v_add_f32 v53, v53, v62
v_cvt_pk_bf16_f32 v62, v62, v62
v_add_f32 v53, v53, v63
v_cvt_pk_bf16_f32 v63, v63, v63
v_and_b32_dpp v48, v60, v12 row_newbcast:4 row_mask:0xf bank_mask:0xf
v_and_b32_dpp v49, v60, v13 row_newbcast:4 row_mask:0xf bank_mask:0xf
v_and_b32_dpp v50, v60, v14 row_newbcast:4 row_mask:0xf bank_mask:0xf
v_and_b32_dpp v51, v60, v15 row_newbcast:4 row_mask:0xf bank_mask:0xf
s_waitcnt vmcnt(6)
v_mfma_f32_16x16x32_bf16 v[40:43], v[44:47], v[128:131], 0
s_cmp_ge_u32 s41, 25
s_cbranch_scc1 L_t114
s_waitcnt vmcnt(5)
s_cmp_ge_u32 s41, 21
s_cbranch_scc1 L_t114
s_waitcnt vmcnt(4)
s_cmp_ge_u32 s41, 17
s_cbranch_scc1 L_t114
s_waitcnt vmcnt(3)
L_t114:
buffer_load_dwordx4 v[156:159], v2, s[44:47], s50 offen offset:3072 nt
s_add_u32 s50, s50, 131072
s_and_b32 s50, s50, 0x3fffff
ds_read_b32 v11, v8 offset:672
v_and_b32_dpp v44, v60, v12 row_newbcast:8 row_mask:0xf bank_mask:0xf
v_and_b32_dpp v45, v60, v13 row_newbcast:8 row_mask:0xf bank_mask:0xf
v_and_b32_dpp v46, v60, v14 row_newbcast:8 row_mask:0xf bank_mask:0xf
v_and_b32_dpp v47, v60, v15 row_newbcast:8 row_mask:0xf bank_mask:0xf
s_waitcnt vmcnt(6)
v_mfma_f32_16x16x32_bf16 v[40:43], v[48:51], v[132:135], v[40:43]
s_cmp_ge_u32 s41, 28
s_cbranch_scc1 L_t115
s_waitcnt vmcnt(5)
s_cmp_ge_u32 s41, 24
s_cbranch_scc1 L_t115
s_waitcnt vmcnt(4)
s_cmp_ge_u32 s41, 20
s_cbranch_scc1 L_t115
s_waitcnt vmcnt(3)
L_t115:
buffer_load_dwordx4 v[160:163], v2, s[44:47], s50 offen offset:0 nt
v_fma_f32 v64, v64, s61, -v54
v_fma_f32 v65, v65, s61, -v54
v_exp_f32 v64, v64
v_exp_f32 v65, v65
s_nop 0
v_add_f32 v53, v53, v64
v_cvt_pk_bf16_f32 v64, v64, v64
v_add_f32 v53, v53, v65
v_cvt_pk_bf16_f32 v65, v65, v65
v_and_b32_dpp v48, v60, v12 row_newbcast:12 row_mask:0xf bank_mask:0xf
v_and_b32_dpp v49, v60, v13 row_newbcast:12 row_mask:0xf bank_mask:0xf
v_and_b32_dpp v50, v60, v14 row_newbcast:12 row_mask:0xf bank_mask:0xf
v_and_b32_dpp v51, v60, v15 row_newbcast:12 row_mask:0xf bank_mask:0xf
s_waitcnt vmcnt(6)
v_mfma_f32_16x16x32_bf16 v[40:43], v[44:47], v[136:139], v[40:43]
s_cmp_ge_u32 s41, 27
s_cbranch_scc1 L_t116
s_waitcnt vmcnt(5)
s_cmp_ge_u32 s41, 23
s_cbranch_scc1 L_t116
s_waitcnt vmcnt(4)
s_cmp_ge_u32 s41, 19
s_cbranch_scc1 L_t116
s_waitcnt vmcnt(3)
L_t116:
buffer_load_dwordx4 v[164:167], v2, s[44:47], s50 offen offset:1024 nt
s_waitcnt lgkmcnt(0)
v_readfirstlane_b32 s41, v11
v_and_b32_dpp v44, v61, v12 row_newbcast:0 row_mask:0xf bank_mask:0xf
v_and_b32_dpp v45, v61, v13 row_newbcast:0 row_mask:0xf bank_mask:0xf
v_and_b32_dpp v46, v61, v14 row_newbcast:0 row_mask:0xf bank_mask:0xf
v_and_b32_dpp v47, v61, v15 row_newbcast:0 row_mask:0xf bank_mask:0xf
s_waitcnt vmcnt(6)
v_mfma_f32_16x16x32_bf16 v[40:43], v[48:51], v[140:143], v[40:43]
s_cmp_ge_u32 s41, 26
s_cbranch_scc1 L_t117
s_waitcnt vmcnt(5)
s_cmp_ge_u32 s41, 22
s_cbranch_scc1 L_t117
s_waitcnt vmcnt(4)
s_cmp_ge_u32 s41, 18
s_cbranch_scc1 L_t117
s_waitcnt vmcnt(3)
L_t117:
buffer_load_dwordx4 v[168:171], v2, s[44:47], s50 offen offset:2048 nt
v_fma_f32 v66, v66, s61, -v54
v_fma_f32 v67, v67, s61, -v54
v_exp_f32 v66, v66
v_exp_f32 v67, v67
s_nop 0
v_add_f32 v53, v53, v66
v_cvt_pk_bf16_f32 v66, v66, v66
v_add_f32 v53, v53, v67
v_cvt_pk_bf16_f32 v67, v67, v67
v_and_b32_dpp v48, v61, v12 row_newbcast:4 row_mask:0xf bank_mask:0xf
v_and_b32_dpp v49, v61, v13 row_newbcast:4 row_mask:0xf bank_mask:0xf
v_and_b32_dpp v50, v61, v14 row_newbcast:4 row_mask:0xf bank_mask:0xf
v_and_b32_dpp v51, v61, v15 row_newbcast:4 row_mask:0xf bank_mask:0xf
s_waitcnt vmcnt(6)
v_mfma_f32_16x16x32_bf16 v[40:43], v[44:47], v[144:147], v[40:43]
s_cmp_ge_u32 s41, 25
s_cbranch_scc1 L_t118
s_waitcnt vmcnt(5)
s_cmp_ge_u32 s41, 21
s_cbranch_scc1 L_t118
s_waitcnt vmcnt(4)
s_cmp_ge_u32 s41, 17
s_cbranch_scc1 L_t118
s_waitcnt vmcnt(3)
L_t118:
buffer_load_dwordx4 v[172:175], v2, s[44:47], s50 offen offset:3072 nt
s_add_u32 s50, s50, 131072
s_and_b32 s50, s50, 0x3fffff
v_and_b32_dpp v44, v61, v12 row_newbcast:8 row_mask:0xf bank_mask:0xf
v_and_b32_dpp v45, v61, v13 row_newbcast:8 row_mask:0xf bank_mask:0xf
v_and_b32_dpp v46, v61, v14 row_newbcast:8 row_mask:0xf bank_mask:0xf
v_and_b32_dpp v47, v61, v15 row_newbcast:8 row_mask:0xf bank_mask:0xf
s_waitcnt vmcnt(6)
v_mfma_f32_16x16x32_bf16 v[40:43], v[48:51], v[148:151], v[40:43]
s_cmp_ge_u32 s41, 28
s_cbranch_scc1 L_t119
s_waitcnt vmcnt(5)
s_cmp_ge_u32 s41, 24
s_cbranch_scc1 L_t119
s_waitcnt vmcnt(4)
s_cmp_ge_u32 s41, 20
s_cbranch_scc1 L_t119
s_waitcnt vmcnt(3)
L_t119:
buffer_load_dwordx4 v[176:179], v2, s[44:47], s50 offen offset:0 nt
v_fma_f32 v68, v68, s61, -v54
v_fma_f32 v69, v69, s61, -v54
v_exp_f32 v68, v68
v_exp_f32 v69, v69
s_nop 0
v_add_f32 v53, v53, v68
v_cvt_pk_bf16_f32 v68, v68, v68
v_add_f32 v53, v53, v69
v_cvt_pk_bf16_f32 v69, v69, v69
v_and_b32_dpp v48, v61, v12 row_newbcast:12 row_mask:0xf bank_mask:0xf
v_and_b32_dpp v49, v61, v13 row_newbcast:12 row_mask:0xf bank_mask:0xf
v_and_b32_dpp v50, v61, v14 row_newbcast:12 row_mask:0xf bank_mask:0xf
v_and_b32_dpp v51, v61, v15 row_newbcast:12 row_mask:0xf bank_mask:0xf
s_waitcnt vmcnt(6)
v_mfma_f32_16x16x32_bf16 v[40:43], v[44:47], v[152:155], v[40:43]
s_cmp_ge_u32 s41, 27
s_cbranch_scc1 L_t120
s_waitcnt vmcnt(5)
s_cmp_ge_u32 s41, 23
s_cbranch_scc1 L_t120
s_waitcnt vmcnt(4)
s_cmp_ge_u32 s41, 19
s_cbranch_scc1 L_t120
s_waitcnt vmcnt(3)
L_t120:
buffer_load_dwordx4 v[180:183], v2, s[44:47], s50 offen offset:1024 nt
v_and_b32_dpp v44, v62, v12 row_newbcast:0 row_mask:0xf bank_mask:0xf
v_and_b32_dpp v45, v62, v13 row_newbcast:0 row_mask:0xf bank_mask:0xf
v_and_b32_dpp v46, v62, v14 row_newbcast:0 row_mask:0xf bank_mask:0xf
v_and_b32_dpp v47, v62, v15 row_newbcast:0 row_mask:0xf bank_mask:0xf
s_waitcnt vmcnt(6)
v_mfma_f32_16x16x32_bf16 v[40:43], v[48:51], v[156:159], v[40:43]
s_cmp_ge_u32 s41, 26
s_cbranch_scc1 L_t121
s_waitcnt vmcnt(5)
s_cmp_ge_u32 s41, 22
s_cbranch_scc1 L_t121
s_waitcnt vmcnt(4)
s_cmp_ge_u32 s41, 18
s_cbranch_scc1 L_t121
s_waitcnt vmcnt(3)
L_t121:
buffer_load_dwordx4 v[184:187], v2, s[44:47], s50 offen offset:2048 nt
v_fma_f32 v70, v70, s61, -v54
v_fma_f32 v71, v71, s61, -v54
v_exp_f32 v70, v70
v_exp_f32 v71, v71
s_nop 0
v_add_f32 v53, v53, v70
v_cvt_pk_bf16_f32 v70, v70, v70
v_add_f32 v53, v53, v71
v_cvt_pk_bf16_f32 v71, v71, v71
v_and_b32_dpp v48, v62, v12 row_newbcast:4 row_mask:0xf bank_mask:0xf
v_and_b32_dpp v49, v62, v13 row_newbcast:4 row_mask:0xf bank_mask:0xf
v_and_b32_dpp v50, v62, v14 row_newbcast:4 row_mask:0xf bank_mask:0xf
v_and_b32_dpp v51, v62, v15 row_newbcast:4 row_mask:0xf bank_mask:0xf
s_waitcnt vmcnt(6)
v_mfma_f32_16x16x32_bf16 v[40:43], v[44:47], v[160:163], v[40:43]
s_cmp_ge_u32 s41, 25
s_cbranch_scc1 L_t122
s_waitcnt vmcnt(5)
s_cmp_ge_u32 s41, 21
s_cbranch_scc1 L_t122
s_waitcnt vmcnt(4)
s_cmp_ge_u32 s41, 17
s_cbranch_scc1 L_t122
s_waitcnt vmcnt(3)
L_t122:
buffer_load_dwordx4 v[188:191], v2, s[44:47], s50 offen offset:3072 nt
s_add_u32 s50, s50, 131072
s_and_b32 s50, s50, 0x3fffff
v_mov_b32 v56, 6
ds_write_b32 v3, v56 offset:640
ds_read_b32 v11, v8 offset:672
v_and_b32_dpp v44, v62, v12 row_newbcast:8 row_mask:0xf bank_mask:0xf
v_and_b32_dpp v45, v62, v13 row_newbcast:8 row_mask:0xf bank_mask:0xf
v_and_b32_dpp v46, v62, v14 row_newbcast:8 row_mask:0xf bank_mask:0xf
v_and_b32_dpp v47, v62, v15 row_newbcast:8 row_mask:0xf bank_mask:0xf
s_waitcnt vmcnt(6)
v_mfma_f32_16x16x32_bf16 v[40:43], v[48:51], v[164:167], v[40:43]
s_cmp_ge_u32 s41, 28
s_cbranch_scc1 L_t123
s_waitcnt vmcnt(5)
s_cmp_ge_u32 s41, 24
s_cbranch_scc1 L_t123
s_waitcnt vmcnt(4)
s_cmp_ge_u32 s41, 20
s_cbranch_scc1 L_t123
s_waitcnt vmcnt(3)
L_t123:
buffer_load_dwordx4 v[192:195], v2, s[44:47], s50 offen offset:0 nt
v_fma_f32 v72, v72, s61, -v54
v_fma_f32 v73, v73, s61, -v54
v_exp_f32 v72, v72
v_exp_f32 v73, v73
s_nop 0
v_add_f32 v53, v53, v72
v_cvt_pk_bf16_f32 v72, v72, v72
v_add_f32 v53, v53, v73
v_cvt_pk_bf16_f32 v73, v73, v73
v_and_b32_dpp v48, v62, v12 row_newbcast:12 row_mask:0xf bank_mask:0xf
v_and_b32_dpp v49, v62, v13 row_newbcast:12 row_mask:0xf bank_mask:0xf
v_and_b32_dpp v50, v62, v14 row_newbcast:12 row_mask:0xf bank_mask:0xf
v_and_b32_dpp v51, v62, v15 row_newbcast:12 row_mask:0xf bank_mask:0xf
s_waitcnt vmcnt(6)
v_mfma_f32_16x16x32_bf16 v[40:43], v[44:47], v[168:171], v[40:43]
s_cmp_ge_u32 s41, 27
s_cbranch_scc1 L_t124
s_waitcnt vmcnt(5)
s_cmp_ge_u32 s41, 23
s_cbranch_scc1 L_t124
s_waitcnt vmcnt(4)
s_cmp_ge_u32 s41, 19
s_cbranch_scc1 L_t124
s_waitcnt vmcnt(3)
L_t124:
buffer_load_dwordx4 v[196:199], v2, s[44:47], s50 offen offset:1024 nt
s_waitcnt lgkmcnt(0)
v_readfirstlane_b32 s41, v11
v_and_b32_dpp v44, v63, v12 row_newbcast:0 row_mask:0xf bank_mask:0xf
v_and_b32_dpp v45, v63, v13 row_newbcast:0 row_mask:0xf bank_mask:0xf
v_and_b32_dpp v46, v63, v14 row_newbcast:0 row_mask:0xf bank_mask:0xf
v_and_b32_dpp v47, v63, v15 row_newbcast:0 row_mask:0xf bank_mask:0xf
s_waitcnt vmcnt(6)
v_mfma_f32_16x16x32_bf16 v[40:43], v[48:51], v[172:175], v[40:43]
s_cmp_ge_u32 s41, 26
s_cbranch_scc1 L_t125
s_waitcnt vmcnt(5)
s_cmp_ge_u32 s41, 22
s_cbranch_scc1 L_t125
s_waitcnt vmcnt(4)
s_cmp_ge_u32 s41, 18
s_cbranch_scc1 L_t125
s_waitcnt vmcnt(3)
L_t125:
buffer_load_dwordx4 v[200:203], v2, s[44:47], s50 offen offset:2048 nt
v_fma_f32 v74, v74, s61, -v54
v_fma_f32 v75, v75, s61, -v54
v_exp_f32 v74, v74
v_exp_f32 v75, v75
s_nop 0
v_add_f32 v53, v53, v74
v_cvt_pk_bf16_f32 v74, v74, v74
v_add_f32 v53, v53, v75
v_cvt_pk_bf16_f32 v75, v75, v75
v_and_b32_dpp v48, v63, v12 row_newbcast:4 row_mask:0xf bank_mask:0xf
v_and_b32_dpp v49, v63, v13 row_newbcast:4 row_mask:0xf bank_mask:0xf
v_and_b32_dpp v50, v63, v14 row_newbcast:4 row_mask:0xf bank_mask:0xf
v_and_b32_dpp v51, v63, v15 row_newbcast:4 row_mask:0xf bank_mask:0xf
s_waitcnt vmcnt(6)
v_mfma_f32_16x16x32_bf16 v[40:43], v[44:47], v[176:179], v[40:43]
s_cmp_ge_u32 s41, 25
s_cbranch_scc1 L_t126
s_waitcnt vmcnt(5)
s_cmp_ge_u32 s41, 21
s_cbranch_scc1 L_t126
s_waitcnt vmcnt(4)
s_cmp_ge_u32 s41, 17
s_cbranch_scc1 L_t126
s_waitcnt vmcnt(3)
L_t126:
buffer_load_dwordx4 v[204:207], v2, s[44:47], s50 offen offset:3072 nt
s_add_u32 s50, s50, 131072
s_and_b32 s50, s50, 0x3fffff
v_and_b32_dpp v44, v63, v12 row_newbcast:8 row_mask:0xf bank_mask:0xf
v_and_b32_dpp v45, v63, v13 row_newbcast:8 row_mask:0xf bank_mask:0xf
v_and_b32_dpp v46, v63, v14 row_newbcast:8 row_mask:0xf bank_mask:0xf
v_and_b32_dpp v47, v63, v15 row_newbcast:8 row_mask:0xf bank_mask:0xf
s_waitcnt vmcnt(6)
v_mfma_f32_16x16x32_bf16 v[40:43], v[48:51], v[180:183], v[40:43]
s_cmp_ge_u32 s41, 28
s_cbranch_scc1 L_t127
s_waitcnt vmcnt(5)
s_cmp_ge_u32 s41, 24
s_cbranch_scc1 L_t127
s_waitcnt vmcnt(4)
s_cmp_ge_u32 s41, 20
s_cbranch_scc1 L_t127
s_waitcnt vmcnt(3)
L_t127:
buffer_load_dwordx4 v[208:211], v2, s[44:47], s50 offen offset:0 nt
v_fma_f32 v76, v76, s61, -v54
v_fma_f32 v77, v77, s61, -v54
v_exp_f32 v76, v76
v_exp_f32 v77, v77
s_nop 0
v_add_f32 v53, v53, v76
v_cvt_pk_bf16_f32 v76, v76, v76
v_add_f32 v53, v53, v77
v_cvt_pk_bf16_f32 v77, v77, v77
v_and_b32_dpp v48, v63, v12 row_newbcast:12 row_mask:0xf bank_mask:0xf
v_and_b32_dpp v49, v63, v13 row_newbcast:12 row_mask:0xf bank_mask:0xf
v_and_b32_dpp v50, v63, v14 row_newbcast:12 row_mask:0xf bank_mask:0xf
v_and_b32_dpp v51, v63, v15 row_newbcast:12 row_mask:0xf bank_mask:0xf
s_waitcnt vmcnt(6)
v_mfma_f32_16x16x32_bf16 v[40:43], v[44:47], v[184:187], v[40:43]
s_cmp_ge_u32 s41, 27
s_cbranch_scc1 L_t128
s_waitcnt vmcnt(5)
s_cmp_ge_u32 s41, 23
s_cbranch_scc1 L_t128
s_waitcnt vmcnt(4)
s_cmp_ge_u32 s41, 19
s_cbranch_scc1 L_t128
s_waitcnt vmcnt(3)
L_t128:
buffer_load_dwordx4 v[212:215], v2, s[44:47], s50 offen offset:1024 nt
v_and_b32_dpp v44, v64, v12 row_newbcast:0 row_mask:0xf bank_mask:0xf
v_and_b32_dpp v45, v64, v13 row_newbcast:0 row_mask:0xf bank_mask:0xf
v_and_b32_dpp v46, v64, v14 row_newbcast:0 row_mask:0xf bank_mask:0xf
v_and_b32_dpp v47, v64, v15 row_newbcast:0 row_mask:0xf bank_mask:0xf
s_waitcnt vmcnt(6)
v_mfma_f32_16x16x32_bf16 v[40:43], v[48:51], v[188:191], v[40:43]
s_cmp_ge_u32 s41, 26
s_cbranch_scc1 L_t129
s_waitcnt vmcnt(5)
s_cmp_ge_u32 s41, 22
s_cbranch_scc1 L_t129
s_waitcnt vmcnt(4)
s_cmp_ge_u32 s41, 18
s_cbranch_scc1 L_t129
s_waitcnt vmcnt(3)
L_t129:
buffer_load_dwordx4 v[216:219], v2, s[44:47], s50 offen offset:2048 nt
v_fma_f32 v78, v78, s61, -v54
v_fma_f32 v79, v79, s61, -v54
v_exp_f32 v78, v78
v_exp_f32 v79, v79
s_nop 0
v_add_f32 v53, v53, v78
v_cvt_pk_bf16_f32 v78, v78, v78
v_add_f32 v53, v53, v79
v_cvt_pk_bf16_f32 v79, v79, v79
v_and_b32_dpp v48, v64, v12 row_newbcast:4 row_mask:0xf bank_mask:0xf
v_and_b32_dpp v49, v64, v13 row_newbcast:4 row_mask:0xf bank_mask:0xf
v_and_b32_dpp v50, v64, v14 row_newbcast:4 row_mask:0xf bank_mask:0xf
v_and_b32_dpp v51, v64, v15 row_newbcast:4 row_mask:0xf bank_mask:0xf
s_waitcnt vmcnt(6)
v_mfma_f32_16x16x32_bf16 v[40:43], v[44:47], v[192:195], v[40:43]
s_cmp_ge_u32 s41, 25
s_cbranch_scc1 L_t130
s_waitcnt vmcnt(5)
s_cmp_ge_u32 s41, 21
s_cbranch_scc1 L_t130
s_waitcnt vmcnt(4)
s_cmp_ge_u32 s41, 17
s_cbranch_scc1 L_t130
s_waitcnt vmcnt(3)
L_t130:
buffer_load_dwordx4 v[220:223], v2, s[44:47], s50 offen offset:3072 nt
s_add_u32 s50, s50, 131072
s_and_b32 s50, s50, 0x3fffff
ds_read_b32 v11, v8 offset:672
v_and_b32_dpp v44, v64, v12 row_newbcast:8 row_mask:0xf bank_mask:0xf
v_and_b32_dpp v45, v64, v13 row_newbcast:8 row_mask:0xf bank_mask:0xf
v_and_b32_dpp v46, v64, v14 row_newbcast:8 row_mask:0xf bank_mask:0xf
v_and_b32_dpp v47, v64, v15 row_newbcast:8 row_mask:0xf bank_mask:0xf
s_waitcnt vmcnt(6)
v_mfma_f32_16x16x32_bf16 v[40:43], v[48:51], v[196:199], v[40:43]
s_cmp_ge_u32 s41, 28
s_cbranch_scc1 L_t131
s_waitcnt vmcnt(5)
s_cmp_ge_u32 s41, 24
s_cbranch_scc1 L_t131
s_waitcnt vmcnt(4)
s_cmp_ge_u32 s41, 20
s_cbranch_scc1 L_t131
s_waitcnt vmcnt(3)
L_t131:
buffer_load_dwordx4 v[224:227], v2, s[44:47], s50 offen offset:0 nt
v_fma_f32 v80, v80, s61, -v54
v_fma_f32 v81, v81, s61, -v54
v_exp_f32 v80, v80
v_exp_f32 v81, v81
s_nop 0
v_add_f32 v53, v53, v80
v_cvt_pk_bf16_f32 v80, v80, v80
v_add_f32 v53, v53, v81
v_cvt_pk_bf16_f32 v81, v81, v81
v_and_b32_dpp v48, v64, v12 row_newbcast:12 row_mask:0xf bank_mask:0xf
v_and_b32_dpp v49, v64, v13 row_newbcast:12 row_mask:0xf bank_mask:0xf
v_and_b32_dpp v50, v64, v14 row_newbcast:12 row_mask:0xf bank_mask:0xf
v_and_b32_dpp v51, v64, v15 row_newbcast:12 row_mask:0xf bank_mask:0xf
s_waitcnt vmcnt(6)
v_mfma_f32_16x16x32_bf16 v[40:43], v[44:47], v[200:203], v[40:43]
s_cmp_ge_u32 s41, 27
s_cbranch_scc1 L_t132
s_waitcnt vmcnt(5)
s_cmp_ge_u32 s41, 23
s_cbranch_scc1 L_t132
s_waitcnt vmcnt(4)
s_cmp_ge_u32 s41, 19
s_cbranch_scc1 L_t132
s_waitcnt vmcnt(3)
L_t132:
buffer_load_dwordx4 v[228:231], v2, s[44:47], s50 offen offset:1024 nt
s_waitcnt lgkmcnt(0)
v_readfirstlane_b32 s41, v11
v_and_b32_dpp v44, v65, v12 row_newbcast:0 row_mask:0xf bank_mask:0xf
v_and_b32_dpp v45, v65, v13 row_newbcast:0 row_mask:0xf bank_mask:0xf
v_and_b32_dpp v46, v65, v14 row_newbcast:0 row_mask:0xf bank_mask:0xf
v_and_b32_dpp v47, v65, v15 row_newbcast:0 row_mask:0xf bank_mask:0xf
s_waitcnt vmcnt(6)
v_mfma_f32_16x16x32_bf16 v[40:43], v[48:51], v[204:207], v[40:43]
s_cmp_ge_u32 s41, 26
s_cbranch_scc1 L_t133
s_waitcnt vmcnt(5)
s_cmp_ge_u32 s41, 22
s_cbranch_scc1 L_t133
s_waitcnt vmcnt(4)
s_cmp_ge_u32 s41, 18
s_cbranch_scc1 L_t133
s_waitcnt vmcnt(3)
L_t133:
buffer_load_dwordx4 v[232:235], v2, s[44:47], s50 offen offset:2048 nt
v_fma_f32 v82, v82, s61, -v54
v_fma_f32 v83, v83, s61, -v54
v_exp_f32 v82, v82
v_exp_f32 v83, v83
s_nop 0
v_add_f32 v53, v53, v82
v_cvt_pk_bf16_f32 v82, v82, v82
v_add_f32 v53, v53, v83
v_cvt_pk_bf16_f32 v83, v83, v83
v_and_b32_dpp v48, v65, v12 row_newbcast:4 row_mask:0xf bank_mask:0xf
v_and_b32_dpp v49, v65, v13 row_newbcast:4 row_mask:0xf bank_mask:0xf
v_and_b32_dpp v50, v65, v14 row_newbcast:4 row_mask:0xf bank_mask:0xf
v_and_b32_dpp v51, v65, v15 row_newbcast:4 row_mask:0xf bank_mask:0xf
s_waitcnt vmcnt(6)
v_mfma_f32_16x16x32_bf16 v[40:43], v[44:47], v[208:211], v[40:43]
s_cmp_ge_u32 s41, 25
s_cbranch_scc1 L_t134
s_waitcnt vmcnt(5)
s_cmp_ge_u32 s41, 21
s_cbranch_scc1 L_t134
s_waitcnt vmcnt(4)
s_cmp_ge_u32 s41, 17
s_cbranch_scc1 L_t134
s_waitcnt vmcnt(3)
L_t134:
buffer_load_dwordx4 v[236:239], v2, s[44:47], s50 offen offset:3072 nt
s_add_u32 s50, s50, 131072
s_and_b32 s50, s50, 0x3fffff
v_and_b32_dpp v44, v65, v12 row_newbcast:8 row_mask:0xf bank_mask:0xf
v_and_b32_dpp v45, v65, v13 row_newbcast:8 row_mask:0xf bank_mask:0xf
v_and_b32_dpp v46, v65, v14 row_newbcast:8 row_mask:0xf bank_mask:0xf
v_and_b32_dpp v47, v65, v15 row_newbcast:8 row_mask:0xf bank_mask:0xf
s_waitcnt vmcnt(6)
v_mfma_f32_16x16x32_bf16 v[40:43], v[48:51], v[212:215], v[40:43]
s_cmp_ge_u32 s41, 28
s_cbranch_scc1 L_t135
s_waitcnt vmcnt(5)
s_cmp_ge_u32 s41, 24
s_cbranch_scc1 L_t135
s_waitcnt vmcnt(4)
s_cmp_ge_u32 s41, 20
s_cbranch_scc1 L_t135
s_waitcnt vmcnt(3)
L_t135:
buffer_load_dwordx4 v[240:243], v2, s[44:47], s50 offen offset:0 nt
v_fma_f32 v84, v84, s61, -v54
v_fma_f32 v85, v85, s61, -v54
v_exp_f32 v84, v84
v_exp_f32 v85, v85
s_nop 0
v_add_f32 v53, v53, v84
v_cvt_pk_bf16_f32 v84, v84, v84
v_add_f32 v53, v53, v85
v_cvt_pk_bf16_f32 v85, v85, v85
v_and_b32_dpp v48, v65, v12 row_newbcast:12 row_mask:0xf bank_mask:0xf
v_and_b32_dpp v49, v65, v13 row_newbcast:12 row_mask:0xf bank_mask:0xf
v_and_b32_dpp v50, v65, v14 row_newbcast:12 row_mask:0xf bank_mask:0xf
v_and_b32_dpp v51, v65, v15 row_newbcast:12 row_mask:0xf bank_mask:0xf
s_waitcnt vmcnt(6)
v_mfma_f32_16x16x32_bf16 v[40:43], v[44:47], v[216:219], v[40:43]
s_cmp_ge_u32 s41, 27
s_cbranch_scc1 L_t136
s_waitcnt vmcnt(5)
s_cmp_ge_u32 s41, 23
s_cbranch_scc1 L_t136
s_waitcnt vmcnt(4)
s_cmp_ge_u32 s41, 19
s_cbranch_scc1 L_t136
s_waitcnt vmcnt(3)
L_t136:
buffer_load_dwordx4 v[244:247], v2, s[44:47], s50 offen offset:1024 nt
v_and_b32_dpp v44, v66, v12 row_newbcast:0 row_mask:0xf bank_mask:0xf
v_and_b32_dpp v45, v66, v13 row_newbcast:0 row_mask:0xf bank_mask:0xf
v_and_b32_dpp v46, v66, v14 row_newbcast:0 row_mask:0xf bank_mask:0xf
v_and_b32_dpp v47, v66, v15 row_newbcast:0 row_mask:0xf bank_mask:0xf
s_waitcnt vmcnt(6)
v_mfma_f32_16x16x32_bf16 v[40:43], v[48:51], v[220:223], v[40:43]
s_cmp_ge_u32 s41, 26
s_cbranch_scc1 L_t137
s_waitcnt vmcnt(5)
s_cmp_ge_u32 s41, 22
s_cbranch_scc1 L_t137
s_waitcnt vmcnt(4)
s_cmp_ge_u32 s41, 18
s_cbranch_scc1 L_t137
s_waitcnt vmcnt(3)
L_t137:
buffer_load_dwordx4 v[248:251], v2, s[44:47], s50 offen offset:2048 nt
v_fma_f32 v86, v86, s61, -v54
v_fma_f32 v87, v87, s61, -v54
v_exp_f32 v86, v86
v_exp_f32 v87, v87
s_nop 0
v_add_f32 v53, v53, v86
v_cvt_pk_bf16_f32 v86, v86, v86
v_add_f32 v53, v53, v87
v_cvt_pk_bf16_f32 v87, v87, v87
v_and_b32_dpp v48, v66, v12 row_newbcast:4 row_mask:0xf bank_mask:0xf
v_and_b32_dpp v49, v66, v13 row_newbcast:4 row_mask:0xf bank_mask:0xf
v_and_b32_dpp v50, v66, v14 row_newbcast:4 row_mask:0xf bank_mask:0xf
v_and_b32_dpp v51, v66, v15 row_newbcast:4 row_mask:0xf bank_mask:0xf
s_waitcnt vmcnt(6)
v_mfma_f32_16x16x32_bf16 v[40:43], v[44:47], v[224:227], v[40:43]
s_cmp_ge_u32 s41, 25
s_cbranch_scc1 L_t138
s_waitcnt vmcnt(5)
s_cmp_ge_u32 s41, 21
s_cbranch_scc1 L_t138
s_waitcnt vmcnt(4)
s_cmp_ge_u32 s41, 17
s_cbranch_scc1 L_t138
s_waitcnt vmcnt(3)
L_t138:
buffer_load_dwordx4 v[252:255], v2, s[44:47], s50 offen offset:3072 nt
s_add_u32 s50, s50, 131072
s_and_b32 s50, s50, 0x3fffff
v_mov_b32 v56, 7
ds_write_b32 v3, v56 offset:640
ds_read_b32 v11, v8 offset:672
v_and_b32_dpp v44, v66, v12 row_newbcast:8 row_mask:0xf bank_mask:0xf
v_and_b32_dpp v45, v66, v13 row_newbcast:8 row_mask:0xf bank_mask:0xf
v_and_b32_dpp v46, v66, v14 row_newbcast:8 row_mask:0xf bank_mask:0xf
v_and_b32_dpp v47, v66, v15 row_newbcast:8 row_mask:0xf bank_mask:0xf
s_waitcnt vmcnt(6)
v_mfma_f32_16x16x32_bf16 v[40:43], v[48:51], v[228:231], v[40:43]
s_cmp_ge_u32 s41, 28
s_cbranch_scc1 L_t139
s_waitcnt vmcnt(5)
s_cmp_ge_u32 s41, 24
s_cbranch_scc1 L_t139
s_waitcnt vmcnt(4)
s_cmp_ge_u32 s41, 20
s_cbranch_scc1 L_t139
s_waitcnt vmcnt(3)
L_t139:
buffer_load_dwordx4 v[96:99], v2, s[44:47], s50 offen offset:0 nt
v_fma_f32 v88, v88, s61, -v54
v_fma_f32 v89, v89, s61, -v54
v_exp_f32 v88, v88
v_exp_f32 v89, v89
s_nop 0
v_add_f32 v53, v53, v88
v_cvt_pk_bf16_f32 v88, v88, v88
v_add_f32 v53, v53, v89
v_cvt_pk_bf16_f32 v89, v89, v89
v_and_b32_dpp v48, v66, v12 row_newbcast:12 row_mask:0xf bank_mask:0xf
v_and_b32_dpp v49, v66, v13 row_newbcast:12 row_mask:0xf bank_mask:0xf
v_and_b32_dpp v50, v66, v14 row_newbcast:12 row_mask:0xf bank_mask:0xf
v_and_b32_dpp v51, v66, v15 row_newbcast:12 row_mask:0xf bank_mask:0xf
s_waitcnt vmcnt(6)
v_mfma_f32_16x16x32_bf16 v[40:43], v[44:47], v[232:235], v[40:43]
s_cmp_ge_u32 s41, 27
s_cbranch_scc1 L_t140
s_waitcnt vmcnt(5)
s_cmp_ge_u32 s41, 23
s_cbranch_scc1 L_t140
s_waitcnt vmcnt(4)
s_cmp_ge_u32 s41, 19
s_cbranch_scc1 L_t140
s_waitcnt vmcnt(3)
L_t140:
buffer_load_dwordx4 v[100:103], v2, s[44:47], s50 offen offset:1024 nt
s_waitcnt lgkmcnt(0)
v_readfirstlane_b32 s41, v11
v_and_b32_dpp v44, v67, v12 row_newbcast:0 row_mask:0xf bank_mask:0xf
v_and_b32_dpp v45, v67, v13 row_newbcast:0 row_mask:0xf bank_mask:0xf
v_and_b32_dpp v46, v67, v14 row_newbcast:0 row_mask:0xf bank_mask:0xf
v_and_b32_dpp v47, v67, v15 row_newbcast:0 row_mask:0xf bank_mask:0xf
s_waitcnt vmcnt(6)
v_mfma_f32_16x16x32_bf16 v[40:43], v[48:51], v[236:239], v[40:43]
s_cmp_ge_u32 s41, 26
s_cbranch_scc1 L_t141
s_waitcnt vmcnt(5)
s_cmp_ge_u32 s41, 22
s_cbranch_scc1 L_t141
s_waitcnt vmcnt(4)
s_cmp_ge_u32 s41, 18
s_cbranch_scc1 L_t141
s_waitcnt vmcnt(3)
L_t141:
buffer_load_dwordx4 v[104:107], v2, s[44:47], s50 offen offset:2048 nt
v_fma_f32 v90, v90, s61, -v54
v_fma_f32 v91, v91, s61, -v54
v_exp_f32 v90, v90
v_exp_f32 v91, v91
s_nop 0
v_add_f32 v53, v53, v90
v_cvt_pk_bf16_f32 v90, v90, v90
v_add_f32 v53, v53, v91
v_cvt_pk_bf16_f32 v91, v91, v91
v_and_b32_dpp v48, v67, v12 row_newbcast:4 row_mask:0xf bank_mask:0xf
v_and_b32_dpp v49, v67, v13 row_newbcast:4 row_mask:0xf bank_mask:0xf
v_and_b32_dpp v50, v67, v14 row_newbcast:4 row_mask:0xf bank_mask:0xf
v_and_b32_dpp v51, v67, v15 row_newbcast:4 row_mask:0xf bank_mask:0xf
s_waitcnt vmcnt(6)
v_mfma_f32_16x16x32_bf16 v[40:43], v[44:47], v[240:243], v[40:43]
s_cmp_ge_u32 s41, 25
s_cbranch_scc1 L_t142
s_waitcnt vmcnt(5)
s_cmp_ge_u32 s41, 21
s_cbranch_scc1 L_t142
s_waitcnt vmcnt(4)
s_cmp_ge_u32 s41, 17
s_cbranch_scc1 L_t142
s_waitcnt vmcnt(3)
L_t142:
buffer_load_dwordx4 v[108:111], v2, s[44:47], s50 offen offset:3072 nt
s_add_u32 s50, s50, 131072
s_and_b32 s50, s50, 0x3fffff
v_and_b32_dpp v44, v67, v12 row_newbcast:8 row_mask:0xf bank_mask:0xf
v_and_b32_dpp v45, v67, v13 row_newbcast:8 row_mask:0xf bank_mask:0xf
v_and_b32_dpp v46, v67, v14 row_newbcast:8 row_mask:0xf bank_mask:0xf
v_and_b32_dpp v47, v67, v15 row_newbcast:8 row_mask:0xf bank_mask:0xf
s_waitcnt vmcnt(6)
v_mfma_f32_16x16x32_bf16 v[40:43], v[48:51], v[244:247], v[40:43]
s_cmp_ge_u32 s41, 28
s_cbranch_scc1 L_t143
s_waitcnt vmcnt(5)
s_cmp_ge_u32 s41, 24
s_cbranch_scc1 L_t143
s_waitcnt vmcnt(4)
s_cmp_ge_u32 s41, 20
s_cbranch_scc1 L_t143
s_waitcnt vmcnt(3)
L_t143:
buffer_load_dwordx4 v[112:115], v2, s[44:47], s50 offen offset:0 nt
v_and_b32_dpp v48, v67, v12 row_newbcast:12 row_mask:0xf bank_mask:0xf
v_and_b32_dpp v49, v67, v13 row_newbcast:12 row_mask:0xf bank_mask:0xf
v_and_b32_dpp v50, v67, v14 row_newbcast:12 row_mask:0xf bank_mask:0xf
v_and_b32_dpp v51, v67, v15 row_newbcast:12 row_mask:0xf bank_mask:0xf
s_waitcnt vmcnt(6)
v_mfma_f32_16x16x32_bf16 v[40:43], v[44:47], v[248:251], v[40:43]
s_cmp_ge_u32 s41, 27
s_cbranch_scc1 L_t144
s_waitcnt vmcnt(5)
s_cmp_ge_u32 s41, 23
s_cbranch_scc1 L_t144
s_waitcnt vmcnt(4)
s_cmp_ge_u32 s41, 19
s_cbranch_scc1 L_t144
s_waitcnt vmcnt(3)
L_t144:
buffer_load_dwordx4 v[116:119], v2, s[44:47], s50 offen offset:1024 nt
v_and_b32_dpp v44, v68, v12 row_newbcast:0 row_mask:0xf bank_mask:0xf
v_and_b32_dpp v45, v68, v13 row_newbcast:0 row_mask:0xf bank_mask:0xf
v_and_b32_dpp v46, v68, v14 row_newbcast:0 row_mask:0xf bank_mask:0xf
v_and_b32_dpp v47, v68, v15 row_newbcast:0 row_mask:0xf bank_mask:0xf
s_waitcnt vmcnt(6)
v_mfma_f32_16x16x32_bf16 v[40:43], v[48:51], v[252:255], v[40:43]
s_cmp_ge_u32 s41, 26
s_cbranch_scc1 L_t145
s_waitcnt vmcnt(5)
s_cmp_ge_u32 s41, 22
s_cbranch_scc1 L_t145
s_waitcnt vmcnt(4)
s_cmp_ge_u32 s41, 18
s_cbranch_scc1 L_t145
s_waitcnt vmcnt(3)
L_t145:
buffer_load_dwordx4 v[120:123], v2, s[44:47], s50 offen offset:2048 nt
v_and_b32_dpp v48, v68, v12 row_newbcast:4 row_mask:0xf bank_mask:0xf
v_and_b32_dpp v49, v68, v13 row_newbcast:4 row_mask:0xf bank_mask:0xf
v_and_b32_dpp v50, v68, v14 row_newbcast:4 row_mask:0xf bank_mask:0xf
v_and_b32_dpp v51, v68, v15 row_newbcast:4 row_mask:0xf bank_mask:0xf
s_waitcnt vmcnt(6)
v_mfma_f32_16x16x32_bf16 v[40:43], v[44:47], v[96:99], v[40:43]
s_cmp_ge_u32 s41, 25
s_cbranch_scc1 L_t146
s_waitcnt vmcnt(5)
s_cmp_ge_u32 s41, 21
s_cbranch_scc1 L_t146
s_waitcnt vmcnt(4)
s_cmp_ge_u32 s41, 17
s_cbranch_scc1 L_t146
s_waitcnt vmcnt(3)
L_t146:
buffer_load_dwordx4 v[124:127], v2, s[44:47], s50 offen offset:3072 nt
s_add_u32 s50, s50, 131072
s_and_b32 s50, s50, 0x3fffff
ds_read_b32 v11, v8 offset:672
v_and_b32_dpp v44, v68, v12 row_newbcast:8 row_mask:0xf bank_mask:0xf
v_and_b32_dpp v45, v68, v13 row_newbcast:8 row_mask:0xf bank_mask:0xf
v_and_b32_dpp v46, v68, v14 row_newbcast:8 row_mask:0xf bank_mask:0xf
v_and_b32_dpp v47, v68, v15 row_newbcast:8 row_mask:0xf bank_mask:0xf
s_waitcnt vmcnt(6)
v_mfma_f32_16x16x32_bf16 v[40:43], v[48:51], v[100:103], v[40:43]
s_cmp_ge_u32 s41, 28
s_cbranch_scc1 L_t147
s_waitcnt vmcnt(5)
s_cmp_ge_u32 s41, 24
s_cbranch_scc1 L_t147
s_waitcnt vmcnt(4)
s_cmp_ge_u32 s41, 20
s_cbranch_scc1 L_t147
s_waitcnt vmcnt(3)
L_t147:
buffer_load_dwordx4 v[128:131], v2, s[44:47], s50 offen offset:0 nt
v_and_b32_dpp v48, v68, v12 row_newbcast:12 row_mask:0xf bank_mask:0xf
v_and_b32_dpp v49, v68, v13 row_newbcast:12 row_mask:0xf bank_mask:0xf
v_and_b32_dpp v50, v68, v14 row_newbcast:12 row_mask:0xf bank_mask:0xf
v_and_b32_dpp v51, v68, v15 row_newbcast:12 row_mask:0xf bank_mask:0xf
s_waitcnt vmcnt(6)
v_mfma_f32_16x16x32_bf16 v[40:43], v[44:47], v[104:107], v[40:43]
s_cmp_ge_u32 s41, 27
s_cbranch_scc1 L_t148
s_waitcnt vmcnt(5)
s_cmp_ge_u32 s41, 23
s_cbranch_scc1 L_t148
s_waitcnt vmcnt(4)
s_cmp_ge_u32 s41, 19
s_cbranch_scc1 L_t148
s_waitcnt vmcnt(3)
L_t148:
buffer_load_dwordx4 v[132:135], v2, s[44:47], s50 offen offset:1024 nt
s_waitcnt lgkmcnt(0)
v_readfirstlane_b32 s41, v11
v_and_b32_dpp v44, v69, v12 row_newbcast:0 row_mask:0xf bank_mask:0xf
v_and_b32_dpp v45, v69, v13 row_newbcast:0 row_mask:0xf bank_mask:0xf
v_and_b32_dpp v46, v69, v14 row_newbcast:0 row_mask:0xf bank_mask:0xf
v_and_b32_dpp v47, v69, v15 row_newbcast:0 row_mask:0xf bank_mask:0xf
s_waitcnt vmcnt(6)
v_mfma_f32_16x16x32_bf16 v[40:43], v[48:51], v[108:111], v[40:43]
s_cmp_ge_u32 s41, 26
s_cbranch_scc1 L_t149
s_waitcnt vmcnt(5)
s_cmp_ge_u32 s41, 22
s_cbranch_scc1 L_t149
s_waitcnt vmcnt(4)
s_cmp_ge_u32 s41, 18
s_cbranch_scc1 L_t149
s_waitcnt vmcnt(3)
L_t149:
buffer_load_dwordx4 v[136:139], v2, s[44:47], s50 offen offset:2048 nt
v_and_b32_dpp v48, v69, v12 row_newbcast:4 row_mask:0xf bank_mask:0xf
v_and_b32_dpp v49, v69, v13 row_newbcast:4 row_mask:0xf bank_mask:0xf
v_and_b32_dpp v50, v69, v14 row_newbcast:4 row_mask:0xf bank_mask:0xf
v_and_b32_dpp v51, v69, v15 row_newbcast:4 row_mask:0xf bank_mask:0xf
s_waitcnt vmcnt(6)
v_mfma_f32_16x16x32_bf16 v[40:43], v[44:47], v[112:115], v[40:43]
s_cmp_ge_u32 s41, 25
s_cbranch_scc1 L_t150
s_waitcnt vmcnt(5)
s_cmp_ge_u32 s41, 21
s_cbranch_scc1 L_t150
s_waitcnt vmcnt(4)
s_cmp_ge_u32 s41, 17
s_cbranch_scc1 L_t150
s_waitcnt vmcnt(3)
L_t150:
buffer_load_dwordx4 v[140:143], v2, s[44:47], s50 offen offset:3072 nt
s_add_u32 s50, s50, 131072
s_and_b32 s50, s50, 0x3fffff
v_and_b32_dpp v44, v69, v12 row_newbcast:8 row_mask:0xf bank_mask:0xf
v_and_b32_dpp v45, v69, v13 row_newbcast:8 row_mask:0xf bank_mask:0xf
v_and_b32_dpp v46, v69, v14 row_newbcast:8 row_mask:0xf bank_mask:0xf
v_and_b32_dpp v47, v69, v15 row_newbcast:8 row_mask:0xf bank_mask:0xf
s_waitcnt vmcnt(6)
v_mfma_f32_16x16x32_bf16 v[40:43], v[48:51], v[116:119], v[40:43]
s_cmp_ge_u32 s41, 28
s_cbranch_scc1 L_t151
s_waitcnt vmcnt(5)
s_cmp_ge_u32 s41, 24
s_cbranch_scc1 L_t151
s_waitcnt vmcnt(4)
s_cmp_ge_u32 s41, 20
s_cbranch_scc1 L_t151
s_waitcnt vmcnt(3)
L_t151:
buffer_load_dwordx4 v[144:147], v2, s[44:47], s50 offen offset:0 nt
v_and_b32_dpp v48, v69, v12 row_newbcast:12 row_mask:0xf bank_mask:0xf
v_and_b32_dpp v49, v69, v13 row_newbcast:12 row_mask:0xf bank_mask:0xf
v_and_b32_dpp v50, v69, v14 row_newbcast:12 row_mask:0xf bank_mask:0xf
v_and_b32_dpp v51, v69, v15 row_newbcast:12 row_mask:0xf bank_mask:0xf
s_waitcnt vmcnt(6)
v_mfma_f32_16x16x32_bf16 v[40:43], v[44:47], v[120:123], v[40:43]
s_cmp_ge_u32 s41, 27
s_cbranch_scc1 L_t152
s_waitcnt vmcnt(5)
s_cmp_ge_u32 s41, 23
s_cbranch_scc1 L_t152
s_waitcnt vmcnt(4)
s_cmp_ge_u32 s41, 19
s_cbranch_scc1 L_t152
s_waitcnt vmcnt(3)
L_t152:
buffer_load_dwordx4 v[148:151], v2, s[44:47], s50 offen offset:1024 nt
v_and_b32_dpp v44, v70, v12 row_newbcast:0 row_mask:0xf bank_mask:0xf
v_and_b32_dpp v45, v70, v13 row_newbcast:0 row_mask:0xf bank_mask:0xf
v_and_b32_dpp v46, v70, v14 row_newbcast:0 row_mask:0xf bank_mask:0xf
v_and_b32_dpp v47, v70, v15 row_newbcast:0 row_mask:0xf bank_mask:0xf
s_waitcnt vmcnt(6)
v_mfma_f32_16x16x32_bf16 v[40:43], v[48:51], v[124:127], v[40:43]
s_cmp_ge_u32 s41, 26
s_cbranch_scc1 L_t153
s_waitcnt vmcnt(5)
s_cmp_ge_u32 s41, 22
s_cbranch_scc1 L_t153
s_waitcnt vmcnt(4)
s_cmp_ge_u32 s41, 18
s_cbranch_scc1 L_t153
s_waitcnt vmcnt(3)
L_t153:
buffer_load_dwordx4 v[152:155], v2, s[44:47], s50 offen offset:2048 nt
s_nop 1
v_add_f32_dpp v53, v53, v53 row_ror:4 row_mask:0xf bank_mask:0xf
s_nop 1
v_add_f32_dpp v53, v53, v53 row_ror:8 row_mask:0xf bank_mask:0xf
s_nop 1
v_add_f32_dpp v53, v53, v53 row_bcast:15 row_mask:0xa bank_mask:0xf
s_nop 1
v_add_f32_dpp v53, v53, v53 row_bcast:31 row_mask:0xc bank_mask:0xf
v_mov_b32 v4, v54
v_mov_b32 v5, s63
v_mov_b32 v6, v53
v_mov_b32 v7, s63
s_mov_b32 exec_lo, 0
s_mov_b32 exec_hi, 0x80000000
ds_write_b128 v58, v[4:7] offset:512
s_mov_b64 exec, -1
v_and_b32_dpp v48, v70, v12 row_newbcast:4 row_mask:0xf bank_mask:0xf
v_and_b32_dpp v49, v70, v13 row_newbcast:4 row_mask:0xf bank_mask:0xf
v_and_b32_dpp v50, v70, v14 row_newbcast:4 row_mask:0xf bank_mask:0xf
v_and_b32_dpp v51, v70, v15 row_newbcast:4 row_mask:0xf bank_mask:0xf
s_waitcnt vmcnt(6)
v_mfma_f32_16x16x32_bf16 v[40:43], v[44:47], v[128:131], v[40:43]
s_cmp_ge_u32 s41, 25
s_cbranch_scc1 L_t154
s_waitcnt vmcnt(5)
s_cmp_ge_u32 s41, 21
s_cbranch_scc1 L_t154
s_waitcnt vmcnt(4)
s_cmp_ge_u32 s41, 17
s_cbranch_scc1 L_t154
s_waitcnt vmcnt(3)
L_t154:
buffer_load_dwordx4 v[156:159], v2, s[44:47], s50 offen offset:3072 nt
s_add_u32 s50, s50, 131072
s_and_b32 s50, s50, 0x3fffff
v_mov_b32 v56, 8
ds_write_b32 v3, v56 offset:640
ds_read_b32 v11, v8 offset:672
v_and_b32_dpp v44, v70, v12 row_newbcast:8 row_mask:0xf bank_mask:0xf
v_and_b32_dpp v45, v70, v13 row_newbcast:8 row_mask:0xf bank_mask:0xf
v_and_b32_dpp v46, v70, v14 row_newbcast:8 row_mask:0xf bank_mask:0xf
v_and_b32_dpp v47, v70, v15 row_newbcast:8 row_mask:0xf bank_mask:0xf
s_waitcnt vmcnt(6)
v_mfma_f32_16x16x32_bf16 v[40:43], v[48:51], v[132:135], v[40:43]
s_cmp_ge_u32 s41, 28
s_cbranch_scc1 L_t155
s_waitcnt vmcnt(5)
s_cmp_ge_u32 s41, 24
s_cbranch_scc1 L_t155
s_waitcnt vmcnt(4)
s_cmp_ge_u32 s41, 20
s_cbranch_scc1 L_t155
s_waitcnt vmcnt(3)
L_t155:
buffer_load_dwordx4 v[160:163], v2, s[44:47], s50 offen offset:0 nt
v_and_b32_dpp v48, v70, v12 row_newbcast:12 row_mask:0xf bank_mask:0xf
v_and_b32_dpp v49, v70, v13 row_newbcast:12 row_mask:0xf bank_mask:0xf
v_and_b32_dpp v50, v70, v14 row_newbcast:12 row_mask:0xf bank_mask:0xf
v_and_b32_dpp v51, v70, v15 row_newbcast:12 row_mask:0xf bank_mask:0xf
s_waitcnt vmcnt(6)
v_mfma_f32_16x16x32_bf16 v[40:43], v[44:47], v[136:139], v[40:43]
s_cmp_ge_u32 s41, 27
s_cbranch_scc1 L_t156
s_waitcnt vmcnt(5)
s_cmp_ge_u32 s41, 23
s_cbranch_scc1 L_t156
s_waitcnt vmcnt(4)
s_cmp_ge_u32 s41, 19
s_cbranch_scc1 L_t156
s_waitcnt vmcnt(3)
L_t156:
buffer_load_dwordx4 v[164:167], v2, s[44:47], s50 offen offset:1024 nt
s_waitcnt lgkmcnt(0)
v_readfirstlane_b32 s41, v11
v_and_b32_dpp v44, v71, v12 row_newbcast:0 row_mask:0xf bank_mask:0xf
v_and_b32_dpp v45, v71, v13 row_newbcast:0 row_mask:0xf bank_mask:0xf
v_and_b32_dpp v46, v71, v14 row_newbcast:0 row_mask:0xf bank_mask:0xf
v_and_b32_dpp v47, v71, v15 row_newbcast:0 row_mask:0xf bank_mask:0xf
s_waitcnt vmcnt(6)
v_mfma_f32_16x16x32_bf16 v[40:43], v[48:51], v[140:143], v[40:43]
s_cmp_ge_u32 s41, 26
s_cbranch_scc1 L_t157
s_waitcnt vmcnt(5)
s_cmp_ge_u32 s41, 22
s_cbranch_scc1 L_t157
s_waitcnt vmcnt(4)
s_cmp_ge_u32 s41, 18
s_cbranch_scc1 L_t157
s_waitcnt vmcnt(3)
L_t157:
buffer_load_dwordx4 v[168:171], v2, s[44:47], s50 offen offset:2048 nt
v_and_b32_dpp v48, v71, v12 row_newbcast:4 row_mask:0xf bank_mask:0xf
v_and_b32_dpp v49, v71, v13 row_newbcast:4 row_mask:0xf bank_mask:0xf
v_and_b32_dpp v50, v71, v14 row_newbcast:4 row_mask:0xf bank_mask:0xf
v_and_b32_dpp v51, v71, v15 row_newbcast:4 row_mask:0xf bank_mask:0xf
s_waitcnt vmcnt(6)
v_mfma_f32_16x16x32_bf16 v[40:43], v[44:47], v[144:147], v[40:43]
s_cmp_ge_u32 s41, 25
s_cbranch_scc1 L_t158
s_waitcnt vmcnt(5)
s_cmp_ge_u32 s41, 21
s_cbranch_scc1 L_t158
s_waitcnt vmcnt(4)
s_cmp_ge_u32 s41, 17
s_cbranch_scc1 L_t158
s_waitcnt vmcnt(3)
L_t158:
buffer_load_dwordx4 v[172:175], v2, s[44:47], s50 offen offset:3072 nt
s_add_u32 s50, s50, 131072
s_and_b32 s50, s50, 0x3fffff
v_and_b32_dpp v44, v71, v12 row_newbcast:8 row_mask:0xf bank_mask:0xf
v_and_b32_dpp v45, v71, v13 row_newbcast:8 row_mask:0xf bank_mask:0xf
v_and_b32_dpp v46, v71, v14 row_newbcast:8 row_mask:0xf bank_mask:0xf
v_and_b32_dpp v47, v71, v15 row_newbcast:8 row_mask:0xf bank_mask:0xf
s_waitcnt vmcnt(6)
v_mfma_f32_16x16x32_bf16 v[40:43], v[48:51], v[148:151], v[40:43]
s_cmp_ge_u32 s41, 28
s_cbranch_scc1 L_t159
s_waitcnt vmcnt(5)
s_cmp_ge_u32 s41, 24
s_cbranch_scc1 L_t159
s_waitcnt vmcnt(4)
s_cmp_ge_u32 s41, 20
s_cbranch_scc1 L_t159
s_waitcnt vmcnt(3)
L_t159:
buffer_load_dwordx4 v[176:179], v2, s[44:47], s50 offen offset:0 nt
v_and_b32_dpp v48, v71, v12 row_newbcast:12 row_mask:0xf bank_mask:0xf
v_and_b32_dpp v49, v71, v13 row_newbcast:12 row_mask:0xf bank_mask:0xf
v_and_b32_dpp v50, v71, v14 row_newbcast:12 row_mask:0xf bank_mask:0xf
v_and_b32_dpp v51, v71, v15 row_newbcast:12 row_mask:0xf bank_mask:0xf
s_waitcnt vmcnt(6)
v_mfma_f32_16x16x32_bf16 v[40:43], v[44:47], v[152:155], v[40:43]
s_cmp_ge_u32 s41, 27
s_cbranch_scc1 L_t160
s_waitcnt vmcnt(5)
s_cmp_ge_u32 s41, 23
s_cbranch_scc1 L_t160
s_waitcnt vmcnt(4)
s_cmp_ge_u32 s41, 19
s_cbranch_scc1 L_t160
s_waitcnt vmcnt(3)
L_t160:
buffer_load_dwordx4 v[180:183], v2, s[44:47], s50 offen offset:1024 nt
v_and_b32_dpp v44, v72, v12 row_newbcast:0 row_mask:0xf bank_mask:0xf
v_and_b32_dpp v45, v72, v13 row_newbcast:0 row_mask:0xf bank_mask:0xf
v_and_b32_dpp v46, v72, v14 row_newbcast:0 row_mask:0xf bank_mask:0xf
v_and_b32_dpp v47, v72, v15 row_newbcast:0 row_mask:0xf bank_mask:0xf
s_waitcnt vmcnt(6)
v_mfma_f32_16x16x32_bf16 v[40:43], v[48:51], v[156:159], v[40:43]
s_cmp_ge_u32 s41, 26
s_cbranch_scc1 L_t161
s_waitcnt vmcnt(5)
s_cmp_ge_u32 s41, 22
s_cbranch_scc1 L_t161
s_waitcnt vmcnt(4)
s_cmp_ge_u32 s41, 18
s_cbranch_scc1 L_t161
s_waitcnt vmcnt(3)
L_t161:
buffer_load_dwordx4 v[184:187], v2, s[44:47], s50 offen offset:2048 nt
v_and_b32_dpp v48, v72, v12 row_newbcast:4 row_mask:0xf bank_mask:0xf
v_and_b32_dpp v49, v72, v13 row_newbcast:4 row_mask:0xf bank_mask:0xf
v_and_b32_dpp v50, v72, v14 row_newbcast:4 row_mask:0xf bank_mask:0xf
v_and_b32_dpp v51, v72, v15 row_newbcast:4 row_mask:0xf bank_mask:0xf
s_waitcnt vmcnt(6)
v_mfma_f32_16x16x32_bf16 v[40:43], v[44:47], v[160:163], v[40:43]
s_cmp_ge_u32 s41, 25
s_cbranch_scc1 L_t162
s_waitcnt vmcnt(5)
s_cmp_ge_u32 s41, 21
s_cbranch_scc1 L_t162
s_waitcnt vmcnt(4)
s_cmp_ge_u32 s41, 17
s_cbranch_scc1 L_t162
s_waitcnt vmcnt(3)
L_t162:
buffer_load_dwordx4 v[188:191], v2, s[44:47], s50 offen offset:3072 nt
s_add_u32 s50, s50, 131072
s_and_b32 s50, s50, 0x3fffff
ds_read_b32 v11, v8 offset:672
v_and_b32_dpp v44, v72, v12 row_newbcast:8 row_mask:0xf bank_mask:0xf
v_and_b32_dpp v45, v72, v13 row_newbcast:8 row_mask:0xf bank_mask:0xf
v_and_b32_dpp v46, v72, v14 row_newbcast:8 row_mask:0xf bank_mask:0xf
v_and_b32_dpp v47, v72, v15 row_newbcast:8 row_mask:0xf bank_mask:0xf
s_waitcnt vmcnt(6)
v_mfma_f32_16x16x32_bf16 v[40:43], v[48:51], v[164:167], v[40:43]
s_cmp_ge_u32 s41, 28
s_cbranch_scc1 L_t163
s_waitcnt vmcnt(5)
s_cmp_ge_u32 s41, 24
s_cbranch_scc1 L_t163
s_waitcnt vmcnt(4)
s_cmp_ge_u32 s41, 20
s_cbranch_scc1 L_t163
s_waitcnt vmcnt(3)
L_t163:
buffer_load_dwordx4 v[192:195], v2, s[44:47], s50 offen offset:0 nt
v_and_b32_dpp v48, v72, v12 row_newbcast:12 row_mask:0xf bank_mask:0xf
v_and_b32_dpp v49, v72, v13 row_newbcast:12 row_mask:0xf bank_mask:0xf
v_and_b32_dpp v50, v72, v14 row_newbcast:12 row_mask:0xf bank_mask:0xf
v_and_b32_dpp v51, v72, v15 row_newbcast:12 row_mask:0xf bank_mask:0xf
s_waitcnt vmcnt(6)
v_mfma_f32_16x16x32_bf16 v[40:43], v[44:47], v[168:171], v[40:43]
s_cmp_ge_u32 s41, 27
s_cbranch_scc1 L_t164
s_waitcnt vmcnt(5)
s_cmp_ge_u32 s41, 23
s_cbranch_scc1 L_t164
s_waitcnt vmcnt(4)
s_cmp_ge_u32 s41, 19
s_cbranch_scc1 L_t164
s_waitcnt vmcnt(3)
L_t164:
buffer_load_dwordx4 v[196:199], v2, s[44:47], s50 offen offset:1024 nt
s_waitcnt lgkmcnt(0)
v_readfirstlane_b32 s41, v11
v_and_b32_dpp v44, v73, v12 row_newbcast:0 row_mask:0xf bank_mask:0xf
v_and_b32_dpp v45, v73, v13 row_newbcast:0 row_mask:0xf bank_mask:0xf
v_and_b32_dpp v46, v73, v14 row_newbcast:0 row_mask:0xf bank_mask:0xf
v_and_b32_dpp v47, v73, v15 row_newbcast:0 row_mask:0xf bank_mask:0xf
s_waitcnt vmcnt(6)
v_mfma_f32_16x16x32_bf16 v[40:43], v[48:51], v[172:175], v[40:43]
s_cmp_ge_u32 s41, 26
s_cbranch_scc1 L_t165
s_waitcnt vmcnt(5)
s_cmp_ge_u32 s41, 22
s_cbranch_scc1 L_t165
s_waitcnt vmcnt(4)
s_cmp_ge_u32 s41, 18
s_cbranch_scc1 L_t165
s_waitcnt vmcnt(3)
L_t165:
buffer_load_dwordx4 v[200:203], v2, s[44:47], s50 offen offset:2048 nt
v_and_b32_dpp v48, v73, v12 row_newbcast:4 row_mask:0xf bank_mask:0xf
v_and_b32_dpp v49, v73, v13 row_newbcast:4 row_mask:0xf bank_mask:0xf
v_and_b32_dpp v50, v73, v14 row_newbcast:4 row_mask:0xf bank_mask:0xf
v_and_b32_dpp v51, v73, v15 row_newbcast:4 row_mask:0xf bank_mask:0xf
s_waitcnt vmcnt(6)
v_mfma_f32_16x16x32_bf16 v[40:43], v[44:47], v[176:179], v[40:43]
s_cmp_ge_u32 s41, 25
s_cbranch_scc1 L_t166
s_waitcnt vmcnt(5)
s_cmp_ge_u32 s41, 21
s_cbranch_scc1 L_t166
s_waitcnt vmcnt(4)
s_cmp_ge_u32 s41, 17
s_cbranch_scc1 L_t166
s_waitcnt vmcnt(3)
L_t166:
buffer_load_dwordx4 v[204:207], v2, s[44:47], s50 offen offset:3072 nt
s_add_u32 s50, s50, 131072
s_and_b32 s50, s50, 0x3fffff
v_and_b32_dpp v44, v73, v12 row_newbcast:8 row_mask:0xf bank_mask:0xf
v_and_b32_dpp v45, v73, v13 row_newbcast:8 row_mask:0xf bank_mask:0xf
v_and_b32_dpp v46, v73, v14 row_newbcast:8 row_mask:0xf bank_mask:0xf
v_and_b32_dpp v47, v73, v15 row_newbcast:8 row_mask:0xf bank_mask:0xf
s_waitcnt vmcnt(6)
v_mfma_f32_16x16x32_bf16 v[40:43], v[48:51], v[180:183], v[40:43]
s_cmp_ge_u32 s41, 28
s_cbranch_scc1 L_t167
s_waitcnt vmcnt(5)
s_cmp_ge_u32 s41, 24
s_cbranch_scc1 L_t167
s_waitcnt vmcnt(4)
s_cmp_ge_u32 s41, 20
s_cbranch_scc1 L_t167
s_waitcnt vmcnt(3)
L_t167:
buffer_load_dwordx4 v[208:211], v2, s[44:47], s50 offen offset:0 nt
v_and_b32_dpp v48, v73, v12 row_newbcast:12 row_mask:0xf bank_mask:0xf
v_and_b32_dpp v49, v73, v13 row_newbcast:12 row_mask:0xf bank_mask:0xf
v_and_b32_dpp v50, v73, v14 row_newbcast:12 row_mask:0xf bank_mask:0xf
v_and_b32_dpp v51, v73, v15 row_newbcast:12 row_mask:0xf bank_mask:0xf
s_waitcnt vmcnt(6)
v_mfma_f32_16x16x32_bf16 v[40:43], v[44:47], v[184:187], v[40:43]
s_cmp_ge_u32 s41, 27
s_cbranch_scc1 L_t168
s_waitcnt vmcnt(5)
s_cmp_ge_u32 s41, 23
s_cbranch_scc1 L_t168
s_waitcnt vmcnt(4)
s_cmp_ge_u32 s41, 19
s_cbranch_scc1 L_t168
s_waitcnt vmcnt(3)
L_t168:
buffer_load_dwordx4 v[212:215], v2, s[44:47], s50 offen offset:1024 nt
v_and_b32_dpp v44, v74, v12 row_newbcast:0 row_mask:0xf bank_mask:0xf
v_and_b32_dpp v45, v74, v13 row_newbcast:0 row_mask:0xf bank_mask:0xf
v_and_b32_dpp v46, v74, v14 row_newbcast:0 row_mask:0xf bank_mask:0xf
v_and_b32_dpp v47, v74, v15 row_newbcast:0 row_mask:0xf bank_mask:0xf
s_waitcnt vmcnt(6)
v_mfma_f32_16x16x32_bf16 v[40:43], v[48:51], v[188:191], v[40:43]
s_cmp_ge_u32 s41, 26
s_cbranch_scc1 L_t169
s_waitcnt vmcnt(5)
s_cmp_ge_u32 s41, 22
s_cbranch_scc1 L_t169
s_waitcnt vmcnt(4)
s_cmp_ge_u32 s41, 18
s_cbranch_scc1 L_t169
s_waitcnt vmcnt(3)
L_t169:
buffer_load_dwordx4 v[216:219], v2, s[44:47], s50 offen offset:2048 nt
v_and_b32_dpp v48, v74, v12 row_newbcast:4 row_mask:0xf bank_mask:0xf
v_and_b32_dpp v49, v74, v13 row_newbcast:4 row_mask:0xf bank_mask:0xf
v_and_b32_dpp v50, v74, v14 row_newbcast:4 row_mask:0xf bank_mask:0xf
v_and_b32_dpp v51, v74, v15 row_newbcast:4 row_mask:0xf bank_mask:0xf
s_waitcnt vmcnt(6)
v_mfma_f32_16x16x32_bf16 v[40:43], v[44:47], v[192:195], v[40:43]
s_cmp_ge_u32 s41, 25
s_cbranch_scc1 L_t170
s_waitcnt vmcnt(5)
s_cmp_ge_u32 s41, 21
s_cbranch_scc1 L_t170
s_waitcnt vmcnt(4)
s_cmp_ge_u32 s41, 17
s_cbranch_scc1 L_t170
s_waitcnt vmcnt(3)
L_t170:
buffer_load_dwordx4 v[220:223], v2, s[44:47], s50 offen offset:3072 nt
s_add_u32 s50, s50, 131072
s_and_b32 s50, s50, 0x3fffff
v_mov_b32 v56, 9
ds_write_b32 v3, v56 offset:640
ds_read_b32 v11, v8 offset:672
v_and_b32_dpp v44, v74, v12 row_newbcast:8 row_mask:0xf bank_mask:0xf
v_and_b32_dpp v45, v74, v13 row_newbcast:8 row_mask:0xf bank_mask:0xf
v_and_b32_dpp v46, v74, v14 row_newbcast:8 row_mask:0xf bank_mask:0xf
v_and_b32_dpp v47, v74, v15 row_newbcast:8 row_mask:0xf bank_mask:0xf
s_waitcnt vmcnt(6)
v_mfma_f32_16x16x32_bf16 v[40:43], v[48:51], v[196:199], v[40:43]
s_cmp_ge_u32 s41, 28
s_cbranch_scc1 L_t171
s_waitcnt vmcnt(5)
s_cmp_ge_u32 s41, 24
s_cbranch_scc1 L_t171
s_waitcnt vmcnt(4)
s_cmp_ge_u32 s41, 20
s_cbranch_scc1 L_t171
s_waitcnt vmcnt(3)
L_t171:
buffer_load_dwordx4 v[224:227], v2, s[44:47], s50 offen offset:0 nt
v_and_b32_dpp v48, v74, v12 row_newbcast:12 row_mask:0xf bank_mask:0xf
v_and_b32_dpp v49, v74, v13 row_newbcast:12 row_mask:0xf bank_mask:0xf
v_and_b32_dpp v50, v74, v14 row_newbcast:12 row_mask:0xf bank_mask:0xf
v_and_b32_dpp v51, v74, v15 row_newbcast:12 row_mask:0xf bank_mask:0xf
s_waitcnt vmcnt(6)
v_mfma_f32_16x16x32_bf16 v[40:43], v[44:47], v[200:203], v[40:43]
s_cmp_ge_u32 s41, 27
s_cbranch_scc1 L_t172
s_waitcnt vmcnt(5)
s_cmp_ge_u32 s41, 23
s_cbranch_scc1 L_t172
s_waitcnt vmcnt(4)
s_cmp_ge_u32 s41, 19
s_cbranch_scc1 L_t172
s_waitcnt vmcnt(3)
L_t172:
buffer_load_dwordx4 v[228:231], v2, s[44:47], s50 offen offset:1024 nt
s_waitcnt lgkmcnt(0)
v_readfirstlane_b32 s41, v11
v_and_b32_dpp v44, v75, v12 row_newbcast:0 row_mask:0xf bank_mask:0xf
v_and_b32_dpp v45, v75, v13 row_newbcast:0 row_mask:0xf bank_mask:0xf
v_and_b32_dpp v46, v75, v14 row_newbcast:0 row_mask:0xf bank_mask:0xf
v_and_b32_dpp v47, v75, v15 row_newbcast:0 row_mask:0xf bank_mask:0xf
s_waitcnt vmcnt(6)
v_mfma_f32_16x16x32_bf16 v[40:43], v[48:51], v[204:207], v[40:43]
s_cmp_ge_u32 s41, 26
s_cbranch_scc1 L_t173
s_waitcnt vmcnt(5)
s_cmp_ge_u32 s41, 22
s_cbranch_scc1 L_t173
s_waitcnt vmcnt(4)
s_cmp_ge_u32 s41, 18
s_cbranch_scc1 L_t173
s_waitcnt vmcnt(3)
L_t173:
buffer_load_dwordx4 v[232:235], v2, s[44:47], s50 offen offset:2048 nt
v_and_b32_dpp v48, v75, v12 row_newbcast:4 row_mask:0xf bank_mask:0xf
v_and_b32_dpp v49, v75, v13 row_newbcast:4 row_mask:0xf bank_mask:0xf
v_and_b32_dpp v50, v75, v14 row_newbcast:4 row_mask:0xf bank_mask:0xf
v_and_b32_dpp v51, v75, v15 row_newbcast:4 row_mask:0xf bank_mask:0xf
s_waitcnt vmcnt(6)
v_mfma_f32_16x16x32_bf16 v[40:43], v[44:47], v[208:211], v[40:43]
s_cmp_ge_u32 s41, 25
s_cbranch_scc1 L_t174
s_waitcnt vmcnt(5)
s_cmp_ge_u32 s41, 21
s_cbranch_scc1 L_t174
s_waitcnt vmcnt(4)
s_cmp_ge_u32 s41, 17
s_cbranch_scc1 L_t174
s_waitcnt vmcnt(3)
L_t174:
buffer_load_dwordx4 v[236:239], v2, s[44:47], s50 offen offset:3072 nt
s_add_u32 s50, s50, 131072
s_and_b32 s50, s50, 0x3fffff
v_and_b32_dpp v44, v75, v12 row_newbcast:8 row_mask:0xf bank_mask:0xf
v_and_b32_dpp v45, v75, v13 row_newbcast:8 row_mask:0xf bank_mask:0xf
v_and_b32_dpp v46, v75, v14 row_newbcast:8 row_mask:0xf bank_mask:0xf
v_and_b32_dpp v47, v75, v15 row_newbcast:8 row_mask:0xf bank_mask:0xf
s_waitcnt vmcnt(6)
v_mfma_f32_16x16x32_bf16 v[40:43], v[48:51], v[212:215], v[40:43]
s_cmp_ge_u32 s41, 28
s_cbranch_scc1 L_t175
s_waitcnt vmcnt(5)
s_cmp_ge_u32 s41, 24
s_cbranch_scc1 L_t175
s_waitcnt vmcnt(4)
s_cmp_ge_u32 s41, 20
s_cbranch_scc1 L_t175
s_waitcnt vmcnt(3)
L_t175:
buffer_load_dwordx4 v[240:243], v2, s[44:47], s50 offen offset:0 nt
v_and_b32_dpp v48, v75, v12 row_newbcast:12 row_mask:0xf bank_mask:0xf
v_and_b32_dpp v49, v75, v13 row_newbcast:12 row_mask:0xf bank_mask:0xf
v_and_b32_dpp v50, v75, v14 row_newbcast:12 row_mask:0xf bank_mask:0xf
v_and_b32_dpp v51, v75, v15 row_newbcast:12 row_mask:0xf bank_mask:0xf
s_waitcnt vmcnt(6)
v_mfma_f32_16x16x32_bf16 v[40:43], v[44:47], v[216:219], v[40:43]
s_cmp_ge_u32 s41, 27
s_cbranch_scc1 L_t176
s_waitcnt vmcnt(5)
s_cmp_ge_u32 s41, 23
s_cbranch_scc1 L_t176
s_waitcnt vmcnt(4)
s_cmp_ge_u32 s41, 19
s_cbranch_scc1 L_t176
s_waitcnt vmcnt(3)
L_t176:
buffer_load_dwordx4 v[244:247], v2, s[44:47], s50 offen offset:1024 nt
v_and_b32_dpp v44, v76, v12 row_newbcast:0 row_mask:0xf bank_mask:0xf
v_and_b32_dpp v45, v76, v13 row_newbcast:0 row_mask:0xf bank_mask:0xf
v_and_b32_dpp v46, v76, v14 row_newbcast:0 row_mask:0xf bank_mask:0xf
v_and_b32_dpp v47, v76, v15 row_newbcast:0 row_mask:0xf bank_mask:0xf
s_waitcnt vmcnt(6)
v_mfma_f32_16x16x32_bf16 v[40:43], v[48:51], v[220:223], v[40:43]
s_cmp_ge_u32 s41, 26
s_cbranch_scc1 L_t177
s_waitcnt vmcnt(5)
s_cmp_ge_u32 s41, 22
s_cbranch_scc1 L_t177
s_waitcnt vmcnt(4)
s_cmp_ge_u32 s41, 18
s_cbranch_scc1 L_t177
s_waitcnt vmcnt(3)
L_t177:
buffer_load_dwordx4 v[248:251], v2, s[44:47], s50 offen offset:2048 nt
v_and_b32_dpp v48, v76, v12 row_newbcast:4 row_mask:0xf bank_mask:0xf
v_and_b32_dpp v49, v76, v13 row_newbcast:4 row_mask:0xf bank_mask:0xf
v_and_b32_dpp v50, v76, v14 row_newbcast:4 row_mask:0xf bank_mask:0xf
v_and_b32_dpp v51, v76, v15 row_newbcast:4 row_mask:0xf bank_mask:0xf
s_waitcnt vmcnt(6)
v_mfma_f32_16x16x32_bf16 v[40:43], v[44:47], v[224:227], v[40:43]
s_cmp_ge_u32 s41, 25
s_cbranch_scc1 L_t178
s_waitcnt vmcnt(5)
s_cmp_ge_u32 s41, 21
s_cbranch_scc1 L_t178
s_waitcnt vmcnt(4)
s_cmp_ge_u32 s41, 17
s_cbranch_scc1 L_t178
s_waitcnt vmcnt(3)
L_t178:
buffer_load_dwordx4 v[252:255], v2, s[44:47], s50 offen offset:3072 nt
s_add_u32 s50, s50, 131072
s_and_b32 s50, s50, 0x3fffff
ds_read_b32 v11, v8 offset:672
v_and_b32_dpp v44, v76, v12 row_newbcast:8 row_mask:0xf bank_mask:0xf
v_and_b32_dpp v45, v76, v13 row_newbcast:8 row_mask:0xf bank_mask:0xf
v_and_b32_dpp v46, v76, v14 row_newbcast:8 row_mask:0xf bank_mask:0xf
v_and_b32_dpp v47, v76, v15 row_newbcast:8 row_mask:0xf bank_mask:0xf
s_waitcnt vmcnt(6)
v_mfma_f32_16x16x32_bf16 v[40:43], v[48:51], v[228:231], v[40:43]
s_cmp_ge_u32 s41, 28
s_cbranch_scc1 L_t179
s_waitcnt vmcnt(5)
s_cmp_ge_u32 s41, 24
s_cbranch_scc1 L_t179
s_waitcnt vmcnt(4)
s_cmp_ge_u32 s41, 20
s_cbranch_scc1 L_t179
s_waitcnt vmcnt(3)
L_t179:
buffer_load_dwordx4 v[96:99], v2, s[44:47], s50 offen offset:0 nt
v_and_b32_dpp v48, v76, v12 row_newbcast:12 row_mask:0xf bank_mask:0xf
v_and_b32_dpp v49, v76, v13 row_newbcast:12 row_mask:0xf bank_mask:0xf
v_and_b32_dpp v50, v76, v14 row_newbcast:12 row_mask:0xf bank_mask:0xf
v_and_b32_dpp v51, v76, v15 row_newbcast:12 row_mask:0xf bank_mask:0xf
s_waitcnt vmcnt(6)
v_mfma_f32_16x16x32_bf16 v[40:43], v[44:47], v[232:235], v[40:43]
s_cmp_ge_u32 s41, 27
s_cbranch_scc1 L_t180
s_waitcnt vmcnt(5)
s_cmp_ge_u32 s41, 23
s_cbranch_scc1 L_t180
s_waitcnt vmcnt(4)
s_cmp_ge_u32 s41, 19
s_cbranch_scc1 L_t180
s_waitcnt vmcnt(3)
L_t180:
buffer_load_dwordx4 v[100:103], v2, s[44:47], s50 offen offset:1024 nt
s_waitcnt lgkmcnt(0)
v_readfirstlane_b32 s41, v11
v_and_b32_dpp v44, v77, v12 row_newbcast:0 row_mask:0xf bank_mask:0xf
v_and_b32_dpp v45, v77, v13 row_newbcast:0 row_mask:0xf bank_mask:0xf
v_and_b32_dpp v46, v77, v14 row_newbcast:0 row_mask:0xf bank_mask:0xf
v_and_b32_dpp v47, v77, v15 row_newbcast:0 row_mask:0xf bank_mask:0xf
s_waitcnt vmcnt(6)
v_mfma_f32_16x16x32_bf16 v[40:43], v[48:51], v[236:239], v[40:43]
s_cmp_ge_u32 s41, 26
s_cbranch_scc1 L_t181
s_waitcnt vmcnt(5)
s_cmp_ge_u32 s41, 22
s_cbranch_scc1 L_t181
s_waitcnt vmcnt(4)
s_cmp_ge_u32 s41, 18
s_cbranch_scc1 L_t181
s_waitcnt vmcnt(3)
L_t181:
buffer_load_dwordx4 v[104:107], v2, s[44:47], s50 offen offset:2048 nt
v_and_b32_dpp v48, v77, v12 row_newbcast:4 row_mask:0xf bank_mask:0xf
v_and_b32_dpp v49, v77, v13 row_newbcast:4 row_mask:0xf bank_mask:0xf
v_and_b32_dpp v50, v77, v14 row_newbcast:4 row_mask:0xf bank_mask:0xf
v_and_b32_dpp v51, v77, v15 row_newbcast:4 row_mask:0xf bank_mask:0xf
s_waitcnt vmcnt(6)
v_mfma_f32_16x16x32_bf16 v[40:43], v[44:47], v[240:243], v[40:43]
s_cmp_ge_u32 s41, 25
s_cbranch_scc1 L_t182
s_waitcnt vmcnt(5)
s_cmp_ge_u32 s41, 21
s_cbranch_scc1 L_t182
s_waitcnt vmcnt(4)
s_cmp_ge_u32 s41, 17
s_cbranch_scc1 L_t182
s_waitcnt vmcnt(3)
L_t182:
buffer_load_dwordx4 v[108:111], v2, s[44:47], s50 offen offset:3072 nt
s_add_u32 s50, s50, 131072
s_and_b32 s50, s50, 0x3fffff
v_and_b32_dpp v44, v77, v12 row_newbcast:8 row_mask:0xf bank_mask:0xf
v_and_b32_dpp v45, v77, v13 row_newbcast:8 row_mask:0xf bank_mask:0xf
v_and_b32_dpp v46, v77, v14 row_newbcast:8 row_mask:0xf bank_mask:0xf
v_and_b32_dpp v47, v77, v15 row_newbcast:8 row_mask:0xf bank_mask:0xf
s_waitcnt vmcnt(6)
v_mfma_f32_16x16x32_bf16 v[40:43], v[48:51], v[244:247], v[40:43]
s_cmp_ge_u32 s41, 28
s_cbranch_scc1 L_t183
s_waitcnt vmcnt(5)
s_cmp_ge_u32 s41, 24
s_cbranch_scc1 L_t183
s_waitcnt vmcnt(4)
s_cmp_ge_u32 s41, 20
s_cbranch_scc1 L_t183
s_waitcnt vmcnt(3)
L_t183:
buffer_load_dwordx4 v[112:115], v2, s[44:47], s50 offen offset:0 nt
v_and_b32_dpp v48, v77, v12 row_newbcast:12 row_mask:0xf bank_mask:0xf
v_and_b32_dpp v49, v77, v13 row_newbcast:12 row_mask:0xf bank_mask:0xf
v_and_b32_dpp v50, v77, v14 row_newbcast:12 row_mask:0xf bank_mask:0xf
v_and_b32_dpp v51, v77, v15 row_newbcast:12 row_mask:0xf bank_mask:0xf
s_waitcnt vmcnt(6)
v_mfma_f32_16x16x32_bf16 v[40:43], v[44:47], v[248:251], v[40:43]
s_cmp_ge_u32 s41, 27
s_cbranch_scc1 L_t184
s_waitcnt vmcnt(5)
s_cmp_ge_u32 s41, 23
s_cbranch_scc1 L_t184
s_waitcnt vmcnt(4)
s_cmp_ge_u32 s41, 19
s_cbranch_scc1 L_t184
s_waitcnt vmcnt(3)
L_t184:
buffer_load_dwordx4 v[116:119], v2, s[44:47], s50 offen offset:1024 nt
v_and_b32_dpp v44, v78, v12 row_newbcast:0 row_mask:0xf bank_mask:0xf
v_and_b32_dpp v45, v78, v13 row_newbcast:0 row_mask:0xf bank_mask:0xf
v_and_b32_dpp v46, v78, v14 row_newbcast:0 row_mask:0xf bank_mask:0xf
v_and_b32_dpp v47, v78, v15 row_newbcast:0 row_mask:0xf bank_mask:0xf
s_waitcnt vmcnt(6)
v_mfma_f32_16x16x32_bf16 v[40:43], v[48:51], v[252:255], v[40:43]
s_cmp_ge_u32 s41, 26
s_cbranch_scc1 L_t185
s_waitcnt vmcnt(5)
s_cmp_ge_u32 s41, 22
s_cbranch_scc1 L_t185
s_waitcnt vmcnt(4)
s_cmp_ge_u32 s41, 18
s_cbranch_scc1 L_t185
s_waitcnt vmcnt(3)
L_t185:
buffer_load_dwordx4 v[120:123], v2, s[44:47], s50 offen offset:2048 nt
v_and_b32_dpp v48, v78, v12 row_newbcast:4 row_mask:0xf bank_mask:0xf
v_and_b32_dpp v49, v78, v13 row_newbcast:4 row_mask:0xf bank_mask:0xf
v_and_b32_dpp v50, v78, v14 row_newbcast:4 row_mask:0xf bank_mask:0xf
v_and_b32_dpp v51, v78, v15 row_newbcast:4 row_mask:0xf bank_mask:0xf
s_waitcnt vmcnt(6)
v_mfma_f32_16x16x32_bf16 v[40:43], v[44:47], v[96:99], v[40:43]
s_cmp_ge_u32 s41, 25
s_cbranch_scc1 L_t186
s_waitcnt vmcnt(5)
s_cmp_ge_u32 s41, 21
s_cbranch_scc1 L_t186
s_waitcnt vmcnt(4)
s_cmp_ge_u32 s41, 17
s_cbranch_scc1 L_t186
s_waitcnt vmcnt(3)
L_t186:
buffer_load_dwordx4 v[124:127], v2, s[44:47], s50 offen offset:3072 nt
s_add_u32 s50, s50, 131072
s_and_b32 s50, s50, 0x3fffff
v_mov_b32 v56, 10
ds_write_b32 v3, v56 offset:640
ds_read_b32 v11, v8 offset:672
v_and_b32_dpp v44, v78, v12 row_newbcast:8 row_mask:0xf bank_mask:0xf
v_and_b32_dpp v45, v78, v13 row_newbcast:8 row_mask:0xf bank_mask:0xf
v_and_b32_dpp v46, v78, v14 row_newbcast:8 row_mask:0xf bank_mask:0xf
v_and_b32_dpp v47, v78, v15 row_newbcast:8 row_mask:0xf bank_mask:0xf
s_waitcnt vmcnt(6)
v_mfma_f32_16x16x32_bf16 v[40:43], v[48:51], v[100:103], v[40:43]
s_cmp_ge_u32 s41, 28
s_cbranch_scc1 L_t187
s_waitcnt vmcnt(5)
s_cmp_ge_u32 s41, 24
s_cbranch_scc1 L_t187
s_waitcnt vmcnt(4)
s_cmp_ge_u32 s41, 20
s_cbranch_scc1 L_t187
s_waitcnt vmcnt(3)
L_t187:
buffer_load_dwordx4 v[128:131], v2, s[44:47], s50 offen offset:0 nt
v_and_b32_dpp v48, v78, v12 row_newbcast:12 row_mask:0xf bank_mask:0xf
v_and_b32_dpp v49, v78, v13 row_newbcast:12 row_mask:0xf bank_mask:0xf
v_and_b32_dpp v50, v78, v14 row_newbcast:12 row_mask:0xf bank_mask:0xf
v_and_b32_dpp v51, v78, v15 row_newbcast:12 row_mask:0xf bank_mask:0xf
s_waitcnt vmcnt(6)
v_mfma_f32_16x16x32_bf16 v[40:43], v[44:47], v[104:107], v[40:43]
s_cmp_ge_u32 s41, 27
s_cbranch_scc1 L_t188
s_waitcnt vmcnt(5)
s_cmp_ge_u32 s41, 23
s_cbranch_scc1 L_t188
s_waitcnt vmcnt(4)
s_cmp_ge_u32 s41, 19
s_cbranch_scc1 L_t188
s_waitcnt vmcnt(3)
L_t188:
buffer_load_dwordx4 v[132:135], v2, s[44:47], s50 offen offset:1024 nt
s_waitcnt lgkmcnt(0)
v_readfirstlane_b32 s41, v11
v_and_b32_dpp v44, v79, v12 row_newbcast:0 row_mask:0xf bank_mask:0xf
v_and_b32_dpp v45, v79, v13 row_newbcast:0 row_mask:0xf bank_mask:0xf
v_and_b32_dpp v46, v79, v14 row_newbcast:0 row_mask:0xf bank_mask:0xf
v_and_b32_dpp v47, v79, v15 row_newbcast:0 row_mask:0xf bank_mask:0xf
s_waitcnt vmcnt(6)
v_mfma_f32_16x16x32_bf16 v[40:43], v[48:51], v[108:111], v[40:43]
s_cmp_ge_u32 s41, 26
s_cbranch_scc1 L_t189
s_waitcnt vmcnt(5)
s_cmp_ge_u32 s41, 22
s_cbranch_scc1 L_t189
s_waitcnt vmcnt(4)
s_cmp_ge_u32 s41, 18
s_cbranch_scc1 L_t189
s_waitcnt vmcnt(3)
L_t189:
buffer_load_dwordx4 v[136:139], v2, s[44:47], s50 offen offset:2048 nt
v_and_b32_dpp v48, v79, v12 row_newbcast:4 row_mask:0xf bank_mask:0xf
v_and_b32_dpp v49, v79, v13 row_newbcast:4 row_mask:0xf bank_mask:0xf
v_and_b32_dpp v50, v79, v14 row_newbcast:4 row_mask:0xf bank_mask:0xf
v_and_b32_dpp v51, v79, v15 row_newbcast:4 row_mask:0xf bank_mask:0xf
s_waitcnt vmcnt(6)
v_mfma_f32_16x16x32_bf16 v[40:43], v[44:47], v[112:115], v[40:43]
s_cmp_ge_u32 s41, 25
s_cbranch_scc1 L_t190
s_waitcnt vmcnt(5)
s_cmp_ge_u32 s41, 21
s_cbranch_scc1 L_t190
s_waitcnt vmcnt(4)
s_cmp_ge_u32 s41, 17
s_cbranch_scc1 L_t190
s_waitcnt vmcnt(3)
L_t190:
buffer_load_dwordx4 v[140:143], v2, s[44:47], s50 offen offset:3072 nt
s_add_u32 s50, s50, 131072
s_and_b32 s50, s50, 0x3fffff
v_and_b32_dpp v44, v79, v12 row_newbcast:8 row_mask:0xf bank_mask:0xf
v_and_b32_dpp v45, v79, v13 row_newbcast:8 row_mask:0xf bank_mask:0xf
v_and_b32_dpp v46, v79, v14 row_newbcast:8 row_mask:0xf bank_mask:0xf
v_and_b32_dpp v47, v79, v15 row_newbcast:8 row_mask:0xf bank_mask:0xf
s_waitcnt vmcnt(6)
v_mfma_f32_16x16x32_bf16 v[40:43], v[48:51], v[116:119], v[40:43]
s_cmp_ge_u32 s41, 28
s_cbranch_scc1 L_t191
s_waitcnt vmcnt(5)
s_cmp_ge_u32 s41, 24
s_cbranch_scc1 L_t191
s_waitcnt vmcnt(4)
s_cmp_ge_u32 s41, 20
s_cbranch_scc1 L_t191
s_waitcnt vmcnt(3)
L_t191:
buffer_load_dwordx4 v[144:147], v2, s[44:47], s50 offen offset:0 nt
v_and_b32_dpp v48, v79, v12 row_newbcast:12 row_mask:0xf bank_mask:0xf
v_and_b32_dpp v49, v79, v13 row_newbcast:12 row_mask:0xf bank_mask:0xf
v_and_b32_dpp v50, v79, v14 row_newbcast:12 row_mask:0xf bank_mask:0xf
v_and_b32_dpp v51, v79, v15 row_newbcast:12 row_mask:0xf bank_mask:0xf
s_waitcnt vmcnt(6)
v_mfma_f32_16x16x32_bf16 v[40:43], v[44:47], v[120:123], v[40:43]
s_cmp_ge_u32 s41, 27
s_cbranch_scc1 L_t192
s_waitcnt vmcnt(5)
s_cmp_ge_u32 s41, 23
s_cbranch_scc1 L_t192
s_waitcnt vmcnt(4)
s_cmp_ge_u32 s41, 19
s_cbranch_scc1 L_t192
s_waitcnt vmcnt(3)
L_t192:
buffer_load_dwordx4 v[148:151], v2, s[44:47], s50 offen offset:1024 nt
v_and_b32_dpp v44, v80, v12 row_newbcast:0 row_mask:0xf bank_mask:0xf
v_and_b32_dpp v45, v80, v13 row_newbcast:0 row_mask:0xf bank_mask:0xf
v_and_b32_dpp v46, v80, v14 row_newbcast:0 row_mask:0xf bank_mask:0xf
v_and_b32_dpp v47, v80, v15 row_newbcast:0 row_mask:0xf bank_mask:0xf
s_waitcnt vmcnt(6)
v_mfma_f32_16x16x32_bf16 v[40:43], v[48:51], v[124:127], v[40:43]
s_cmp_ge_u32 s41, 26
s_cbranch_scc1 L_t193
s_waitcnt vmcnt(5)
s_cmp_ge_u32 s41, 22
s_cbranch_scc1 L_t193
s_waitcnt vmcnt(4)
s_cmp_ge_u32 s41, 18
s_cbranch_scc1 L_t193
s_waitcnt vmcnt(3)
L_t193:
buffer_load_dwordx4 v[152:155], v2, s[44:47], s50 offen offset:2048 nt
v_and_b32_dpp v48, v80, v12 row_newbcast:4 row_mask:0xf bank_mask:0xf
v_and_b32_dpp v49, v80, v13 row_newbcast:4 row_mask:0xf bank_mask:0xf
v_and_b32_dpp v50, v80, v14 row_newbcast:4 row_mask:0xf bank_mask:0xf
v_and_b32_dpp v51, v80, v15 row_newbcast:4 row_mask:0xf bank_mask:0xf
s_waitcnt vmcnt(6)
v_mfma_f32_16x16x32_bf16 v[40:43], v[44:47], v[128:131], v[40:43]
s_cmp_ge_u32 s41, 25
s_cbranch_scc1 L_t194
s_waitcnt vmcnt(5)
s_cmp_ge_u32 s41, 21
s_cbranch_scc1 L_t194
s_waitcnt vmcnt(4)
s_cmp_ge_u32 s41, 17
s_cbranch_scc1 L_t194
s_waitcnt vmcnt(3)
L_t194:
buffer_load_dwordx4 v[156:159], v2, s[44:47], s50 offen offset:3072 nt
s_add_u32 s50, s50, 131072
s_and_b32 s50, s50, 0x3fffff
ds_read_b32 v11, v8 offset:672
v_and_b32_dpp v44, v80, v12 row_newbcast:8 row_mask:0xf bank_mask:0xf
v_and_b32_dpp v45, v80, v13 row_newbcast:8 row_mask:0xf bank_mask:0xf
v_and_b32_dpp v46, v80, v14 row_newbcast:8 row_mask:0xf bank_mask:0xf
v_and_b32_dpp v47, v80, v15 row_newbcast:8 row_mask:0xf bank_mask:0xf
s_waitcnt vmcnt(6)
v_mfma_f32_16x16x32_bf16 v[40:43], v[48:51], v[132:135], v[40:43]
s_cmp_ge_u32 s41, 28
s_cbranch_scc1 L_t195
s_waitcnt vmcnt(5)
s_cmp_ge_u32 s41, 24
s_cbranch_scc1 L_t195
s_waitcnt vmcnt(4)
s_cmp_ge_u32 s41, 20
s_cbranch_scc1 L_t195
s_waitcnt vmcnt(3)
L_t195:
buffer_load_dwordx4 v[160:163], v2, s[44:47], s50 offen offset:0 nt
v_and_b32_dpp v48, v80, v12 row_newbcast:12 row_mask:0xf bank_mask:0xf
v_and_b32_dpp v49, v80, v13 row_newbcast:12 row_mask:0xf bank_mask:0xf
v_and_b32_dpp v50, v80, v14 row_newbcast:12 row_mask:0xf bank_mask:0xf
v_and_b32_dpp v51, v80, v15 row_newbcast:12 row_mask:0xf bank_mask:0xf
s_waitcnt vmcnt(6)
v_mfma_f32_16x16x32_bf16 v[40:43], v[44:47], v[136:139], v[40:43]
s_cmp_ge_u32 s41, 27
s_cbranch_scc1 L_t196
s_waitcnt vmcnt(5)
s_cmp_ge_u32 s41, 23
s_cbranch_scc1 L_t196
s_waitcnt vmcnt(4)
s_cmp_ge_u32 s41, 19
s_cbranch_scc1 L_t196
s_waitcnt vmcnt(3)
L_t196:
buffer_load_dwordx4 v[164:167], v2, s[44:47], s50 offen offset:1024 nt
s_waitcnt lgkmcnt(0)
v_readfirstlane_b32 s41, v11
v_and_b32_dpp v44, v81, v12 row_newbcast:0 row_mask:0xf bank_mask:0xf
v_and_b32_dpp v45, v81, v13 row_newbcast:0 row_mask:0xf bank_mask:0xf
v_and_b32_dpp v46, v81, v14 row_newbcast:0 row_mask:0xf bank_mask:0xf
v_and_b32_dpp v47, v81, v15 row_newbcast:0 row_mask:0xf bank_mask:0xf
s_waitcnt vmcnt(6)
v_mfma_f32_16x16x32_bf16 v[40:43], v[48:51], v[140:143], v[40:43]
s_cmp_ge_u32 s41, 26
s_cbranch_scc1 L_t197
s_waitcnt vmcnt(5)
s_cmp_ge_u32 s41, 22
s_cbranch_scc1 L_t197
s_waitcnt vmcnt(4)
s_cmp_ge_u32 s41, 18
s_cbranch_scc1 L_t197
s_waitcnt vmcnt(3)
L_t197:
buffer_load_dwordx4 v[168:171], v2, s[44:47], s50 offen offset:2048 nt
v_and_b32_dpp v48, v81, v12 row_newbcast:4 row_mask:0xf bank_mask:0xf
v_and_b32_dpp v49, v81, v13 row_newbcast:4 row_mask:0xf bank_mask:0xf
v_and_b32_dpp v50, v81, v14 row_newbcast:4 row_mask:0xf bank_mask:0xf
v_and_b32_dpp v51, v81, v15 row_newbcast:4 row_mask:0xf bank_mask:0xf
s_waitcnt vmcnt(6)
v_mfma_f32_16x16x32_bf16 v[40:43], v[44:47], v[144:147], v[40:43]
s_cmp_ge_u32 s41, 25
s_cbranch_scc1 L_t198
s_waitcnt vmcnt(5)
s_cmp_ge_u32 s41, 21
s_cbranch_scc1 L_t198
s_waitcnt vmcnt(4)
s_cmp_ge_u32 s41, 17
s_cbranch_scc1 L_t198
s_waitcnt vmcnt(3)
L_t198:
buffer_load_dwordx4 v[172:175], v2, s[44:47], s50 offen offset:3072 nt
s_add_u32 s50, s50, 131072
s_and_b32 s50, s50, 0x3fffff
v_and_b32_dpp v44, v81, v12 row_newbcast:8 row_mask:0xf bank_mask:0xf
v_and_b32_dpp v45, v81, v13 row_newbcast:8 row_mask:0xf bank_mask:0xf
v_and_b32_dpp v46, v81, v14 row_newbcast:8 row_mask:0xf bank_mask:0xf
v_and_b32_dpp v47, v81, v15 row_newbcast:8 row_mask:0xf bank_mask:0xf
s_waitcnt vmcnt(6)
v_mfma_f32_16x16x32_bf16 v[40:43], v[48:51], v[148:151], v[40:43]
s_cmp_ge_u32 s41, 28
s_cbranch_scc1 L_t199
s_waitcnt vmcnt(5)
s_cmp_ge_u32 s41, 24
s_cbranch_scc1 L_t199
s_waitcnt vmcnt(4)
s_cmp_ge_u32 s41, 20
s_cbranch_scc1 L_t199
s_waitcnt vmcnt(3)
L_t199:
buffer_load_dwordx4 v[176:179], v2, s[44:47], s50 offen offset:0 nt
v_and_b32_dpp v48, v81, v12 row_newbcast:12 row_mask:0xf bank_mask:0xf
v_and_b32_dpp v49, v81, v13 row_newbcast:12 row_mask:0xf bank_mask:0xf
v_and_b32_dpp v50, v81, v14 row_newbcast:12 row_mask:0xf bank_mask:0xf
v_and_b32_dpp v51, v81, v15 row_newbcast:12 row_mask:0xf bank_mask:0xf
s_waitcnt vmcnt(6)
v_mfma_f32_16x16x32_bf16 v[40:43], v[44:47], v[152:155], v[40:43]
s_cmp_ge_u32 s41, 27
s_cbranch_scc1 L_t200
s_waitcnt vmcnt(5)
s_cmp_ge_u32 s41, 23
s_cbranch_scc1 L_t200
s_waitcnt vmcnt(4)
s_cmp_ge_u32 s41, 19
s_cbranch_scc1 L_t200
s_waitcnt vmcnt(3)
L_t200:
buffer_load_dwordx4 v[180:183], v2, s[44:47], s50 offen offset:1024 nt
v_and_b32_dpp v44, v82, v12 row_newbcast:0 row_mask:0xf bank_mask:0xf
v_and_b32_dpp v45, v82, v13 row_newbcast:0 row_mask:0xf bank_mask:0xf
v_and_b32_dpp v46, v82, v14 row_newbcast:0 row_mask:0xf bank_mask:0xf
v_and_b32_dpp v47, v82, v15 row_newbcast:0 row_mask:0xf bank_mask:0xf
s_waitcnt vmcnt(6)
v_mfma_f32_16x16x32_bf16 v[40:43], v[48:51], v[156:159], v[40:43]
s_cmp_ge_u32 s41, 26
s_cbranch_scc1 L_t201
s_waitcnt vmcnt(5)
s_cmp_ge_u32 s41, 22
s_cbranch_scc1 L_t201
s_waitcnt vmcnt(4)
s_cmp_ge_u32 s41, 18
s_cbranch_scc1 L_t201
s_waitcnt vmcnt(3)
L_t201:
buffer_load_dwordx4 v[184:187], v2, s[44:47], s50 offen offset:2048 nt
v_and_b32_dpp v48, v82, v12 row_newbcast:4 row_mask:0xf bank_mask:0xf
v_and_b32_dpp v49, v82, v13 row_newbcast:4 row_mask:0xf bank_mask:0xf
v_and_b32_dpp v50, v82, v14 row_newbcast:4 row_mask:0xf bank_mask:0xf
v_and_b32_dpp v51, v82, v15 row_newbcast:4 row_mask:0xf bank_mask:0xf
s_waitcnt vmcnt(6)
v_mfma_f32_16x16x32_bf16 v[40:43], v[44:47], v[160:163], v[40:43]
s_cmp_ge_u32 s41, 25
s_cbranch_scc1 L_t202
s_waitcnt vmcnt(5)
s_cmp_ge_u32 s41, 21
s_cbranch_scc1 L_t202
s_waitcnt vmcnt(4)
s_cmp_ge_u32 s41, 17
s_cbranch_scc1 L_t202
s_waitcnt vmcnt(3)
L_t202:
buffer_load_dwordx4 v[188:191], v2, s[44:47], s50 offen offset:3072 nt
s_add_u32 s50, s50, 131072
s_and_b32 s50, s50, 0x3fffff
v_mov_b32 v56, 11
ds_write_b32 v3, v56 offset:640
ds_read_b32 v11, v8 offset:672
v_and_b32_dpp v44, v82, v12 row_newbcast:8 row_mask:0xf bank_mask:0xf
v_and_b32_dpp v45, v82, v13 row_newbcast:8 row_mask:0xf bank_mask:0xf
v_and_b32_dpp v46, v82, v14 row_newbcast:8 row_mask:0xf bank_mask:0xf
v_and_b32_dpp v47, v82, v15 row_newbcast:8 row_mask:0xf bank_mask:0xf
s_waitcnt vmcnt(6)
v_mfma_f32_16x16x32_bf16 v[40:43], v[48:51], v[164:167], v[40:43]
s_cmp_ge_u32 s41, 28
s_cbranch_scc1 L_t203
s_waitcnt vmcnt(5)
s_cmp_ge_u32 s41, 24
s_cbranch_scc1 L_t203
s_waitcnt vmcnt(4)
s_cmp_ge_u32 s41, 20
s_cbranch_scc1 L_t203
s_waitcnt vmcnt(3)
L_t203:
buffer_load_dwordx4 v[192:195], v2, s[44:47], s50 offen offset:0 nt
v_and_b32_dpp v48, v82, v12 row_newbcast:12 row_mask:0xf bank_mask:0xf
v_and_b32_dpp v49, v82, v13 row_newbcast:12 row_mask:0xf bank_mask:0xf
v_and_b32_dpp v50, v82, v14 row_newbcast:12 row_mask:0xf bank_mask:0xf
v_and_b32_dpp v51, v82, v15 row_newbcast:12 row_mask:0xf bank_mask:0xf
s_waitcnt vmcnt(6)
v_mfma_f32_16x16x32_bf16 v[40:43], v[44:47], v[168:171], v[40:43]
s_cmp_ge_u32 s41, 27
s_cbranch_scc1 L_t204
s_waitcnt vmcnt(5)
s_cmp_ge_u32 s41, 23
s_cbranch_scc1 L_t204
s_waitcnt vmcnt(4)
s_cmp_ge_u32 s41, 19
s_cbranch_scc1 L_t204
s_waitcnt vmcnt(3)
L_t204:
buffer_load_dwordx4 v[196:199], v2, s[44:47], s50 offen offset:1024 nt
s_waitcnt lgkmcnt(0)
v_readfirstlane_b32 s41, v11
v_and_b32_dpp v44, v83, v12 row_newbcast:0 row_mask:0xf bank_mask:0xf
v_and_b32_dpp v45, v83, v13 row_newbcast:0 row_mask:0xf bank_mask:0xf
v_and_b32_dpp v46, v83, v14 row_newbcast:0 row_mask:0xf bank_mask:0xf
v_and_b32_dpp v47, v83, v15 row_newbcast:0 row_mask:0xf bank_mask:0xf
s_waitcnt vmcnt(6)
v_mfma_f32_16x16x32_bf16 v[40:43], v[48:51], v[172:175], v[40:43]
s_cmp_ge_u32 s41, 26
s_cbranch_scc1 L_t205
s_waitcnt vmcnt(5)
s_cmp_ge_u32 s41, 22
s_cbranch_scc1 L_t205
s_waitcnt vmcnt(4)
s_cmp_ge_u32 s41, 18
s_cbranch_scc1 L_t205
s_waitcnt vmcnt(3)
L_t205:
buffer_load_dwordx4 v[200:203], v2, s[44:47], s50 offen offset:2048 nt
v_and_b32_dpp v48, v83, v12 row_newbcast:4 row_mask:0xf bank_mask:0xf
v_and_b32_dpp v49, v83, v13 row_newbcast:4 row_mask:0xf bank_mask:0xf
v_and_b32_dpp v50, v83, v14 row_newbcast:4 row_mask:0xf bank_mask:0xf
v_and_b32_dpp v51, v83, v15 row_newbcast:4 row_mask:0xf bank_mask:0xf
s_waitcnt vmcnt(6)
v_mfma_f32_16x16x32_bf16 v[40:43], v[44:47], v[176:179], v[40:43]
s_cmp_ge_u32 s41, 25
s_cbranch_scc1 L_t206
s_waitcnt vmcnt(5)
s_cmp_ge_u32 s41, 21
s_cbranch_scc1 L_t206
s_waitcnt vmcnt(4)
s_cmp_ge_u32 s41, 17
s_cbranch_scc1 L_t206
s_waitcnt vmcnt(3)
L_t206:
buffer_load_dwordx4 v[204:207], v2, s[44:47], s50 offen offset:3072 nt
s_add_u32 s50, s50, 131072
s_and_b32 s50, s50, 0x3fffff
v_and_b32_dpp v44, v83, v12 row_newbcast:8 row_mask:0xf bank_mask:0xf
v_and_b32_dpp v45, v83, v13 row_newbcast:8 row_mask:0xf bank_mask:0xf
v_and_b32_dpp v46, v83, v14 row_newbcast:8 row_mask:0xf bank_mask:0xf
v_and_b32_dpp v47, v83, v15 row_newbcast:8 row_mask:0xf bank_mask:0xf
s_waitcnt vmcnt(6)
v_mfma_f32_16x16x32_bf16 v[40:43], v[48:51], v[180:183], v[40:43]
s_cmp_ge_u32 s41, 28
s_cbranch_scc1 L_t207
s_waitcnt vmcnt(5)
s_cmp_ge_u32 s41, 24
s_cbranch_scc1 L_t207
s_waitcnt vmcnt(4)
s_cmp_ge_u32 s41, 20
s_cbranch_scc1 L_t207
s_waitcnt vmcnt(3)
L_t207:
buffer_load_dwordx4 v[208:211], v2, s[44:47], s50 offen offset:0 nt
v_and_b32_dpp v48, v83, v12 row_newbcast:12 row_mask:0xf bank_mask:0xf
v_and_b32_dpp v49, v83, v13 row_newbcast:12 row_mask:0xf bank_mask:0xf
v_and_b32_dpp v50, v83, v14 row_newbcast:12 row_mask:0xf bank_mask:0xf
v_and_b32_dpp v51, v83, v15 row_newbcast:12 row_mask:0xf bank_mask:0xf
s_waitcnt vmcnt(6)
v_mfma_f32_16x16x32_bf16 v[40:43], v[44:47], v[184:187], v[40:43]
s_cmp_ge_u32 s41, 27
s_cbranch_scc1 L_t208
s_waitcnt vmcnt(5)
s_cmp_ge_u32 s41, 23
s_cbranch_scc1 L_t208
s_waitcnt vmcnt(4)
s_cmp_ge_u32 s41, 19
s_cbranch_scc1 L_t208
s_waitcnt vmcnt(3)
L_t208:
buffer_load_dwordx4 v[212:215], v2, s[44:47], s50 offen offset:1024 nt
v_and_b32_dpp v44, v84, v12 row_newbcast:0 row_mask:0xf bank_mask:0xf
v_and_b32_dpp v45, v84, v13 row_newbcast:0 row_mask:0xf bank_mask:0xf
v_and_b32_dpp v46, v84, v14 row_newbcast:0 row_mask:0xf bank_mask:0xf
v_and_b32_dpp v47, v84, v15 row_newbcast:0 row_mask:0xf bank_mask:0xf
s_waitcnt vmcnt(6)
v_mfma_f32_16x16x32_bf16 v[40:43], v[48:51], v[188:191], v[40:43]
s_cmp_ge_u32 s41, 26
s_cbranch_scc1 L_t209
s_waitcnt vmcnt(5)
s_cmp_ge_u32 s41, 22
s_cbranch_scc1 L_t209
s_waitcnt vmcnt(4)
s_cmp_ge_u32 s41, 18
s_cbranch_scc1 L_t209
s_waitcnt vmcnt(3)
L_t209:
buffer_load_dwordx4 v[216:219], v2, s[44:47], s50 offen offset:2048 nt
v_and_b32_dpp v48, v84, v12 row_newbcast:4 row_mask:0xf bank_mask:0xf
v_and_b32_dpp v49, v84, v13 row_newbcast:4 row_mask:0xf bank_mask:0xf
v_and_b32_dpp v50, v84, v14 row_newbcast:4 row_mask:0xf bank_mask:0xf
v_and_b32_dpp v51, v84, v15 row_newbcast:4 row_mask:0xf bank_mask:0xf
s_waitcnt vmcnt(6)
v_mfma_f32_16x16x32_bf16 v[40:43], v[44:47], v[192:195], v[40:43]
s_cmp_ge_u32 s41, 25
s_cbranch_scc1 L_t210
s_waitcnt vmcnt(5)
s_cmp_ge_u32 s41, 21
s_cbranch_scc1 L_t210
s_waitcnt vmcnt(4)
s_cmp_ge_u32 s41, 17
s_cbranch_scc1 L_t210
s_waitcnt vmcnt(3)
L_t210:
buffer_load_dwordx4 v[220:223], v2, s[44:47], s50 offen offset:3072 nt
s_add_u32 s50, s50, 131072
s_and_b32 s50, s50, 0x3fffff
ds_read_b32 v11, v8 offset:672
v_and_b32_dpp v44, v84, v12 row_newbcast:8 row_mask:0xf bank_mask:0xf
v_and_b32_dpp v45, v84, v13 row_newbcast:8 row_mask:0xf bank_mask:0xf
v_and_b32_dpp v46, v84, v14 row_newbcast:8 row_mask:0xf bank_mask:0xf
v_and_b32_dpp v47, v84, v15 row_newbcast:8 row_mask:0xf bank_mask:0xf
s_waitcnt vmcnt(6)
v_mfma_f32_16x16x32_bf16 v[40:43], v[48:51], v[196:199], v[40:43]
s_cmp_ge_u32 s41, 28
s_cbranch_scc1 L_t211
s_waitcnt vmcnt(5)
s_cmp_ge_u32 s41, 24
s_cbranch_scc1 L_t211
s_waitcnt vmcnt(4)
s_cmp_ge_u32 s41, 20
s_cbranch_scc1 L_t211
s_waitcnt vmcnt(3)
L_t211:
buffer_load_dwordx4 v[224:227], v2, s[44:47], s50 offen offset:0 nt
v_and_b32_dpp v48, v84, v12 row_newbcast:12 row_mask:0xf bank_mask:0xf
v_and_b32_dpp v49, v84, v13 row_newbcast:12 row_mask:0xf bank_mask:0xf
v_and_b32_dpp v50, v84, v14 row_newbcast:12 row_mask:0xf bank_mask:0xf
v_and_b32_dpp v51, v84, v15 row_newbcast:12 row_mask:0xf bank_mask:0xf
s_waitcnt vmcnt(6)
v_mfma_f32_16x16x32_bf16 v[40:43], v[44:47], v[200:203], v[40:43]
s_cmp_ge_u32 s41, 27
s_cbranch_scc1 L_t212
s_waitcnt vmcnt(5)
s_cmp_ge_u32 s41, 23
s_cbranch_scc1 L_t212
s_waitcnt vmcnt(4)
s_cmp_ge_u32 s41, 19
s_cbranch_scc1 L_t212
s_waitcnt vmcnt(3)
L_t212:
buffer_load_dwordx4 v[228:231], v2, s[44:47], s50 offen offset:1024 nt
s_waitcnt lgkmcnt(0)
v_readfirstlane_b32 s41, v11
v_and_b32_dpp v44, v85, v12 row_newbcast:0 row_mask:0xf bank_mask:0xf
v_and_b32_dpp v45, v85, v13 row_newbcast:0 row_mask:0xf bank_mask:0xf
v_and_b32_dpp v46, v85, v14 row_newbcast:0 row_mask:0xf bank_mask:0xf
v_and_b32_dpp v47, v85, v15 row_newbcast:0 row_mask:0xf bank_mask:0xf
s_waitcnt vmcnt(6)
v_mfma_f32_16x16x32_bf16 v[40:43], v[48:51], v[204:207], v[40:43]
s_cmp_ge_u32 s41, 26
s_cbranch_scc1 L_t213
s_waitcnt vmcnt(5)
s_cmp_ge_u32 s41, 22
s_cbranch_scc1 L_t213
s_waitcnt vmcnt(4)
s_cmp_ge_u32 s41, 18
s_cbranch_scc1 L_t213
s_waitcnt vmcnt(3)
L_t213:
buffer_load_dwordx4 v[232:235], v2, s[44:47], s50 offen offset:2048 nt
v_and_b32_dpp v48, v85, v12 row_newbcast:4 row_mask:0xf bank_mask:0xf
v_and_b32_dpp v49, v85, v13 row_newbcast:4 row_mask:0xf bank_mask:0xf
v_and_b32_dpp v50, v85, v14 row_newbcast:4 row_mask:0xf bank_mask:0xf
v_and_b32_dpp v51, v85, v15 row_newbcast:4 row_mask:0xf bank_mask:0xf
s_waitcnt vmcnt(6)
v_mfma_f32_16x16x32_bf16 v[40:43], v[44:47], v[208:211], v[40:43]
s_cmp_ge_u32 s41, 25
s_cbranch_scc1 L_t214
s_waitcnt vmcnt(5)
s_cmp_ge_u32 s41, 21
s_cbranch_scc1 L_t214
s_waitcnt vmcnt(4)
s_cmp_ge_u32 s41, 17
s_cbranch_scc1 L_t214
s_waitcnt vmcnt(3)
L_t214:
buffer_load_dwordx4 v[236:239], v2, s[44:47], s50 offen offset:3072 nt
s_add_u32 s50, s50, 131072
s_and_b32 s50, s50, 0x3fffff
v_and_b32_dpp v44, v85, v12 row_newbcast:8 row_mask:0xf bank_mask:0xf
v_and_b32_dpp v45, v85, v13 row_newbcast:8 row_mask:0xf bank_mask:0xf
v_and_b32_dpp v46, v85, v14 row_newbcast:8 row_mask:0xf bank_mask:0xf
v_and_b32_dpp v47, v85, v15 row_newbcast:8 row_mask:0xf bank_mask:0xf
s_waitcnt vmcnt(6)
v_mfma_f32_16x16x32_bf16 v[40:43], v[48:51], v[212:215], v[40:43]
s_cmp_ge_u32 s41, 28
s_cbranch_scc1 L_t215
s_waitcnt vmcnt(5)
s_cmp_ge_u32 s41, 24
s_cbranch_scc1 L_t215
s_waitcnt vmcnt(4)
s_cmp_ge_u32 s41, 20
s_cbranch_scc1 L_t215
s_waitcnt vmcnt(3)
L_t215:
buffer_load_dwordx4 v[240:243], v2, s[44:47], s50 offen offset:0 nt
v_and_b32_dpp v48, v85, v12 row_newbcast:12 row_mask:0xf bank_mask:0xf
v_and_b32_dpp v49, v85, v13 row_newbcast:12 row_mask:0xf bank_mask:0xf
v_and_b32_dpp v50, v85, v14 row_newbcast:12 row_mask:0xf bank_mask:0xf
v_and_b32_dpp v51, v85, v15 row_newbcast:12 row_mask:0xf bank_mask:0xf
s_waitcnt vmcnt(6)
v_mfma_f32_16x16x32_bf16 v[40:43], v[44:47], v[216:219], v[40:43]
s_cmp_ge_u32 s41, 27
s_cbranch_scc1 L_t216
s_waitcnt vmcnt(5)
s_cmp_ge_u32 s41, 23
s_cbranch_scc1 L_t216
s_waitcnt vmcnt(4)
s_cmp_ge_u32 s41, 19
s_cbranch_scc1 L_t216
s_waitcnt vmcnt(3)
L_t216:
buffer_load_dwordx4 v[244:247], v2, s[44:47], s50 offen offset:1024 nt
v_and_b32_dpp v44, v86, v12 row_newbcast:0 row_mask:0xf bank_mask:0xf
v_and_b32_dpp v45, v86, v13 row_newbcast:0 row_mask:0xf bank_mask:0xf
v_and_b32_dpp v46, v86, v14 row_newbcast:0 row_mask:0xf bank_mask:0xf
v_and_b32_dpp v47, v86, v15 row_newbcast:0 row_mask:0xf bank_mask:0xf
s_waitcnt vmcnt(6)
v_mfma_f32_16x16x32_bf16 v[40:43], v[48:51], v[220:223], v[40:43]
s_cmp_ge_u32 s41, 26
s_cbranch_scc1 L_t217
s_waitcnt vmcnt(5)
s_cmp_ge_u32 s41, 22
s_cbranch_scc1 L_t217
s_waitcnt vmcnt(4)
s_cmp_ge_u32 s41, 18
s_cbranch_scc1 L_t217
s_waitcnt vmcnt(3)
L_t217:
buffer_load_dwordx4 v[248:251], v2, s[44:47], s50 offen offset:2048 nt
v_and_b32_dpp v48, v86, v12 row_newbcast:4 row_mask:0xf bank_mask:0xf
v_and_b32_dpp v49, v86, v13 row_newbcast:4 row_mask:0xf bank_mask:0xf
v_and_b32_dpp v50, v86, v14 row_newbcast:4 row_mask:0xf bank_mask:0xf
v_and_b32_dpp v51, v86, v15 row_newbcast:4 row_mask:0xf bank_mask:0xf
s_waitcnt vmcnt(6)
v_mfma_f32_16x16x32_bf16 v[40:43], v[44:47], v[224:227], v[40:43]
s_cmp_ge_u32 s41, 25
s_cbranch_scc1 L_t218
s_waitcnt vmcnt(5)
s_cmp_ge_u32 s41, 21
s_cbranch_scc1 L_t218
s_waitcnt vmcnt(4)
s_cmp_ge_u32 s41, 17
s_cbranch_scc1 L_t218
s_waitcnt vmcnt(3)
L_t218:
buffer_load_dwordx4 v[252:255], v2, s[44:47], s50 offen offset:3072 nt
s_add_u32 s50, s50, 131072
s_and_b32 s50, s50, 0x3fffff
ds_read_b32 v11, v8 offset:672
v_and_b32_dpp v44, v86, v12 row_newbcast:8 row_mask:0xf bank_mask:0xf
v_and_b32_dpp v45, v86, v13 row_newbcast:8 row_mask:0xf bank_mask:0xf
v_and_b32_dpp v46, v86, v14 row_newbcast:8 row_mask:0xf bank_mask:0xf
v_and_b32_dpp v47, v86, v15 row_newbcast:8 row_mask:0xf bank_mask:0xf
s_waitcnt vmcnt(6)
v_mfma_f32_16x16x32_bf16 v[40:43], v[48:51], v[228:231], v[40:43]
s_cmp_ge_u32 s41, 28
s_cbranch_scc1 L_t219
s_waitcnt vmcnt(5)
s_cmp_ge_u32 s41, 24
s_cbranch_scc1 L_t219
s_waitcnt vmcnt(4)
s_cmp_ge_u32 s41, 20
s_cbranch_scc1 L_t219
s_waitcnt vmcnt(3)
L_t219:
buffer_load_dwordx4 v[96:99], v2, s[44:47], s50 offen offset:0 nt
v_and_b32_dpp v48, v86, v12 row_newbcast:12 row_mask:0xf bank_mask:0xf
v_and_b32_dpp v49, v86, v13 row_newbcast:12 row_mask:0xf bank_mask:0xf
v_and_b32_dpp v50, v86, v14 row_newbcast:12 row_mask:0xf bank_mask:0xf
v_and_b32_dpp v51, v86, v15 row_newbcast:12 row_mask:0xf bank_mask:0xf
s_waitcnt vmcnt(6)
v_mfma_f32_16x16x32_bf16 v[40:43], v[44:47], v[232:235], v[40:43]
s_cmp_ge_u32 s41, 27
s_cbranch_scc1 L_t220
s_waitcnt vmcnt(5)
s_cmp_ge_u32 s41, 23
s_cbranch_scc1 L_t220
s_waitcnt vmcnt(4)
s_cmp_ge_u32 s41, 19
s_cbranch_scc1 L_t220
s_waitcnt vmcnt(3)
L_t220:
buffer_load_dwordx4 v[100:103], v2, s[44:47], s50 offen offset:1024 nt
s_waitcnt lgkmcnt(0)
v_readfirstlane_b32 s41, v11
v_and_b32_dpp v44, v87, v12 row_newbcast:0 row_mask:0xf bank_mask:0xf
v_and_b32_dpp v45, v87, v13 row_newbcast:0 row_mask:0xf bank_mask:0xf
v_and_b32_dpp v46, v87, v14 row_newbcast:0 row_mask:0xf bank_mask:0xf
v_and_b32_dpp v47, v87, v15 row_newbcast:0 row_mask:0xf bank_mask:0xf
s_waitcnt vmcnt(6)
v_mfma_f32_16x16x32_bf16 v[40:43], v[48:51], v[236:239], v[40:43]
s_cmp_ge_u32 s41, 26
s_cbranch_scc1 L_t221
s_waitcnt vmcnt(5)
s_cmp_ge_u32 s41, 22
s_cbranch_scc1 L_t221
s_waitcnt vmcnt(4)
s_cmp_ge_u32 s41, 18
s_cbranch_scc1 L_t221
s_waitcnt vmcnt(3)
L_t221:
buffer_load_dwordx4 v[104:107], v2, s[44:47], s50 offen offset:2048 nt
v_and_b32_dpp v48, v87, v12 row_newbcast:4 row_mask:0xf bank_mask:0xf
v_and_b32_dpp v49, v87, v13 row_newbcast:4 row_mask:0xf bank_mask:0xf
v_and_b32_dpp v50, v87, v14 row_newbcast:4 row_mask:0xf bank_mask:0xf
v_and_b32_dpp v51, v87, v15 row_newbcast:4 row_mask:0xf bank_mask:0xf
s_waitcnt vmcnt(6)
v_mfma_f32_16x16x32_bf16 v[40:43], v[44:47], v[240:243], v[40:43]
s_cmp_ge_u32 s41, 25
s_cbranch_scc1 L_t222
s_waitcnt vmcnt(5)
s_cmp_ge_u32 s41, 21
s_cbranch_scc1 L_t222
s_waitcnt vmcnt(4)
s_cmp_ge_u32 s41, 17
s_cbranch_scc1 L_t222
s_waitcnt vmcnt(3)
L_t222:
buffer_load_dwordx4 v[108:111], v2, s[44:47], s50 offen offset:3072 nt
s_add_u32 s50, s50, 131072
s_and_b32 s50, s50, 0x3fffff
v_and_b32_dpp v44, v87, v12 row_newbcast:8 row_mask:0xf bank_mask:0xf
v_and_b32_dpp v45, v87, v13 row_newbcast:8 row_mask:0xf bank_mask:0xf
v_and_b32_dpp v46, v87, v14 row_newbcast:8 row_mask:0xf bank_mask:0xf
v_and_b32_dpp v47, v87, v15 row_newbcast:8 row_mask:0xf bank_mask:0xf
s_waitcnt vmcnt(6)
v_mfma_f32_16x16x32_bf16 v[40:43], v[48:51], v[244:247], v[40:43]
s_cmp_ge_u32 s41, 28
s_cbranch_scc1 L_t223
s_waitcnt vmcnt(5)
s_cmp_ge_u32 s41, 24
s_cbranch_scc1 L_t223
s_waitcnt vmcnt(4)
s_cmp_ge_u32 s41, 20
s_cbranch_scc1 L_t223
s_waitcnt vmcnt(3)
L_t223:
buffer_load_dwordx4 v[112:115], v2, s[44:47], s50 offen offset:0 nt
v_and_b32_dpp v48, v87, v12 row_newbcast:12 row_mask:0xf bank_mask:0xf
v_and_b32_dpp v49, v87, v13 row_newbcast:12 row_mask:0xf bank_mask:0xf
v_and_b32_dpp v50, v87, v14 row_newbcast:12 row_mask:0xf bank_mask:0xf
v_and_b32_dpp v51, v87, v15 row_newbcast:12 row_mask:0xf bank_mask:0xf
s_waitcnt vmcnt(6)
v_mfma_f32_16x16x32_bf16 v[40:43], v[44:47], v[248:251], v[40:43]
s_cmp_ge_u32 s41, 27
s_cbranch_scc1 L_t224
s_waitcnt vmcnt(5)
s_cmp_ge_u32 s41, 23
s_cbranch_scc1 L_t224
s_waitcnt vmcnt(4)
s_cmp_ge_u32 s41, 19
s_cbranch_scc1 L_t224
s_waitcnt vmcnt(3)
L_t224:
buffer_load_dwordx4 v[116:119], v2, s[44:47], s50 offen offset:1024 nt
v_and_b32_dpp v44, v88, v12 row_newbcast:0 row_mask:0xf bank_mask:0xf
v_and_b32_dpp v45, v88, v13 row_newbcast:0 row_mask:0xf bank_mask:0xf
v_and_b32_dpp v46, v88, v14 row_newbcast:0 row_mask:0xf bank_mask:0xf
v_and_b32_dpp v47, v88, v15 row_newbcast:0 row_mask:0xf bank_mask:0xf
s_waitcnt vmcnt(6)
v_mfma_f32_16x16x32_bf16 v[40:43], v[48:51], v[252:255], v[40:43]
s_cmp_ge_u32 s41, 26
s_cbranch_scc1 L_t225
s_waitcnt vmcnt(5)
s_cmp_ge_u32 s41, 22
s_cbranch_scc1 L_t225
s_waitcnt vmcnt(4)
s_cmp_ge_u32 s41, 18
s_cbranch_scc1 L_t225
s_waitcnt vmcnt(3)
L_t225:
buffer_load_dwordx4 v[120:123], v2, s[44:47], s50 offen offset:2048 nt
ds_read_b64 v[4:5], v9 offset:576
v_and_b32_dpp v48, v88, v12 row_newbcast:4 row_mask:0xf bank_mask:0xf
v_and_b32_dpp v49, v88, v13 row_newbcast:4 row_mask:0xf bank_mask:0xf
v_and_b32_dpp v50, v88, v14 row_newbcast:4 row_mask:0xf bank_mask:0xf
v_and_b32_dpp v51, v88, v15 row_newbcast:4 row_mask:0xf bank_mask:0xf
s_waitcnt vmcnt(6)
v_mfma_f32_16x16x32_bf16 v[40:43], v[44:47], v[96:99], v[40:43]
s_cmp_ge_u32 s41, 25
s_cbranch_scc1 L_t226
s_waitcnt vmcnt(5)
s_cmp_ge_u32 s41, 21
s_cbranch_scc1 L_t226
s_waitcnt vmcnt(4)
s_cmp_ge_u32 s41, 17
s_cbranch_scc1 L_t226
s_waitcnt vmcnt(3)
L_t226:
buffer_load_dwordx4 v[124:127], v2, s[44:47], s50 offen offset:3072 nt
s_add_u32 s50, s50, 131072
s_and_b32 s50, s50, 0x3fffff
ds_read_b32 v11, v8 offset:672
v_and_b32_dpp v44, v88, v12 row_newbcast:8 row_mask:0xf bank_mask:0xf
v_and_b32_dpp v45, v88, v13 row_newbcast:8 row_mask:0xf bank_mask:0xf
v_and_b32_dpp v46, v88, v14 row_newbcast:8 row_mask:0xf bank_mask:0xf
v_and_b32_dpp v47, v88, v15 row_newbcast:8 row_mask:0xf bank_mask:0xf
s_waitcnt vmcnt(6)
v_mfma_f32_16x16x32_bf16 v[40:43], v[48:51], v[100:103], v[40:43]
s_cmp_ge_u32 s41, 28
s_cbranch_scc1 L_t227
s_waitcnt vmcnt(5)
s_cmp_ge_u32 s41, 24
s_cbranch_scc1 L_t227
s_waitcnt vmcnt(4)
s_cmp_ge_u32 s41, 20
s_cbranch_scc1 L_t227
s_waitcnt vmcnt(3)
L_t227:
buffer_load_dwordx4 v[128:131], v2, s[44:47], s50 offen offset:0 nt
v_and_b32_dpp v48, v88, v12 row_newbcast:12 row_mask:0xf bank_mask:0xf
v_and_b32_dpp v49, v88, v13 row_newbcast:12 row_mask:0xf bank_mask:0xf
v_and_b32_dpp v50, v88, v14 row_newbcast:12 row_mask:0xf bank_mask:0xf
v_and_b32_dpp v51, v88, v15 row_newbcast:12 row_mask:0xf bank_mask:0xf
s_waitcnt vmcnt(6)
v_mfma_f32_16x16x32_bf16 v[40:43], v[44:47], v[104:107], v[40:43]
s_cmp_ge_u32 s41, 27
s_cbranch_scc1 L_t228
s_waitcnt vmcnt(5)
s_cmp_ge_u32 s41, 23
s_cbranch_scc1 L_t228
s_waitcnt vmcnt(4)
s_cmp_ge_u32 s41, 19
s_cbranch_scc1 L_t228
s_waitcnt vmcnt(3)
L_t228:
buffer_load_dwordx4 v[132:135], v2, s[44:47], s50 offen offset:1024 nt
s_waitcnt lgkmcnt(0)
v_readfirstlane_b32 s41, v11
v_and_b32_dpp v44, v89, v12 row_newbcast:0 row_mask:0xf bank_mask:0xf
v_and_b32_dpp v45, v89, v13 row_newbcast:0 row_mask:0xf bank_mask:0xf
v_and_b32_dpp v46, v89, v14 row_newbcast:0 row_mask:0xf bank_mask:0xf
v_and_b32_dpp v47, v89, v15 row_newbcast:0 row_mask:0xf bank_mask:0xf
s_waitcnt vmcnt(6)
v_mfma_f32_16x16x32_bf16 v[40:43], v[48:51], v[108:111], v[40:43]
s_cmp_ge_u32 s41, 26
s_cbranch_scc1 L_t229
s_waitcnt vmcnt(5)
s_cmp_ge_u32 s41, 22
s_cbranch_scc1 L_t229
s_waitcnt vmcnt(4)
s_cmp_ge_u32 s41, 18
s_cbranch_scc1 L_t229
s_waitcnt vmcnt(3)
L_t229:
buffer_load_dwordx4 v[136:139], v2, s[44:47], s50 offen offset:2048 nt
v_and_b32_dpp v48, v89, v12 row_newbcast:4 row_mask:0xf bank_mask:0xf
v_and_b32_dpp v49, v89, v13 row_newbcast:4 row_mask:0xf bank_mask:0xf
v_and_b32_dpp v50, v89, v14 row_newbcast:4 row_mask:0xf bank_mask:0xf
v_and_b32_dpp v51, v89, v15 row_newbcast:4 row_mask:0xf bank_mask:0xf
s_waitcnt vmcnt(6)
v_mfma_f32_16x16x32_bf16 v[40:43], v[44:47], v[112:115], v[40:43]
s_cmp_ge_u32 s41, 25
s_cbranch_scc1 L_t230
s_waitcnt vmcnt(5)
s_cmp_ge_u32 s41, 21
s_cbranch_scc1 L_t230
s_waitcnt vmcnt(4)
s_cmp_ge_u32 s41, 17
s_cbranch_scc1 L_t230
s_waitcnt vmcnt(3)
L_t230:
buffer_load_dwordx4 v[140:143], v2, s[44:47], s50 offen offset:3072 nt
s_add_u32 s50, s50, 131072
s_and_b32 s50, s50, 0x3fffff
v_and_b32_dpp v44, v89, v12 row_newbcast:8 row_mask:0xf bank_mask:0xf
v_and_b32_dpp v45, v89, v13 row_newbcast:8 row_mask:0xf bank_mask:0xf
v_and_b32_dpp v46, v89, v14 row_newbcast:8 row_mask:0xf bank_mask:0xf
v_and_b32_dpp v47, v89, v15 row_newbcast:8 row_mask:0xf bank_mask:0xf
s_waitcnt vmcnt(6)
v_mfma_f32_16x16x32_bf16 v[40:43], v[48:51], v[116:119], v[40:43]
s_cmp_ge_u32 s41, 28
s_cbranch_scc1 L_t231
s_waitcnt vmcnt(5)
s_cmp_ge_u32 s41, 24
s_cbranch_scc1 L_t231
s_waitcnt vmcnt(4)
s_cmp_ge_u32 s41, 20
s_cbranch_scc1 L_t231
s_waitcnt vmcnt(3)
L_t231:
buffer_load_dwordx4 v[144:147], v2, s[44:47], s50 offen offset:0 nt
v_and_b32_dpp v48, v89, v12 row_newbcast:12 row_mask:0xf bank_mask:0xf
v_and_b32_dpp v49, v89, v13 row_newbcast:12 row_mask:0xf bank_mask:0xf
v_and_b32_dpp v50, v89, v14 row_newbcast:12 row_mask:0xf bank_mask:0xf
v_and_b32_dpp v51, v89, v15 row_newbcast:12 row_mask:0xf bank_mask:0xf
s_waitcnt vmcnt(6)
v_mfma_f32_16x16x32_bf16 v[40:43], v[44:47], v[120:123], v[40:43]
s_cmp_ge_u32 s41, 27
s_cbranch_scc1 L_t232
s_waitcnt vmcnt(5)
s_cmp_ge_u32 s41, 23
s_cbranch_scc1 L_t232
s_waitcnt vmcnt(4)
s_cmp_ge_u32 s41, 19
s_cbranch_scc1 L_t232
s_waitcnt vmcnt(3)
L_t232:
buffer_load_dwordx4 v[148:151], v2, s[44:47], s50 offen offset:1024 nt
v_and_b32_dpp v44, v90, v12 row_newbcast:0 row_mask:0xf bank_mask:0xf
v_and_b32_dpp v45, v90, v13 row_newbcast:0 row_mask:0xf bank_mask:0xf
v_and_b32_dpp v46, v90, v14 row_newbcast:0 row_mask:0xf bank_mask:0xf
v_and_b32_dpp v47, v90, v15 row_newbcast:0 row_mask:0xf bank_mask:0xf
s_waitcnt vmcnt(6)
v_mfma_f32_16x16x32_bf16 v[40:43], v[48:51], v[124:127], v[40:43]
s_cmp_ge_u32 s41, 26
s_cbranch_scc1 L_t233
s_waitcnt vmcnt(5)
s_cmp_ge_u32 s41, 22
s_cbranch_scc1 L_t233
s_waitcnt vmcnt(4)
s_cmp_ge_u32 s41, 18
s_cbranch_scc1 L_t233
s_waitcnt vmcnt(3)
L_t233:
buffer_load_dwordx4 v[152:155], v2, s[44:47], s50 offen offset:2048 nt
v_and_b32_dpp v48, v90, v12 row_newbcast:4 row_mask:0xf bank_mask:0xf
v_and_b32_dpp v49, v90, v13 row_newbcast:4 row_mask:0xf bank_mask:0xf
v_and_b32_dpp v50, v90, v14 row_newbcast:4 row_mask:0xf bank_mask:0xf
v_and_b32_dpp v51, v90, v15 row_newbcast:4 row_mask:0xf bank_mask:0xf
s_waitcnt vmcnt(6)
v_mfma_f32_16x16x32_bf16 v[40:43], v[44:47], v[128:131], v[40:43]
s_cmp_ge_u32 s41, 25
s_cbranch_scc1 L_t234
s_waitcnt vmcnt(5)
s_cmp_ge_u32 s41, 21
s_cbranch_scc1 L_t234
s_waitcnt vmcnt(4)
s_cmp_ge_u32 s41, 17
s_cbranch_scc1 L_t234
s_waitcnt vmcnt(3)
L_t234:
buffer_load_dwordx4 v[156:159], v2, s[44:47], s50 offen offset:3072 nt
s_add_u32 s50, s50, 131072
s_and_b32 s50, s50, 0x3fffff
v_mov_b32 v56, 100
ds_write_b32 v3, v56 offset:656
ds_read_b32 v11, v8 offset:672
v_and_b32_dpp v44, v90, v12 row_newbcast:8 row_mask:0xf bank_mask:0xf
v_and_b32_dpp v45, v90, v13 row_newbcast:8 row_mask:0xf bank_mask:0xf
v_and_b32_dpp v46, v90, v14 row_newbcast:8 row_mask:0xf bank_mask:0xf
v_and_b32_dpp v47, v90, v15 row_newbcast:8 row_mask:0xf bank_mask:0xf
s_waitcnt vmcnt(6)
v_mfma_f32_16x16x32_bf16 v[40:43], v[48:51], v[132:135], v[40:43]
v_and_b32_dpp v48, v90, v12 row_newbcast:12 row_mask:0xf bank_mask:0xf
v_and_b32_dpp v49, v90, v13 row_newbcast:12 row_mask:0xf bank_mask:0xf
v_and_b32_dpp v50, v90, v14 row_newbcast:12 row_mask:0xf bank_mask:0xf
v_and_b32_dpp v51, v90, v15 row_newbcast:12 row_mask:0xf bank_mask:0xf
s_waitcnt vmcnt(5)
v_mfma_f32_16x16x32_bf16 v[40:43], v[44:47], v[136:139], v[40:43]
v_and_b32_dpp v44, v91, v12 row_newbcast:0 row_mask:0xf bank_mask:0xf
v_and_b32_dpp v45, v91, v13 row_newbcast:0 row_mask:0xf bank_mask:0xf
v_and_b32_dpp v46, v91, v14 row_newbcast:0 row_mask:0xf bank_mask:0xf
v_and_b32_dpp v47, v91, v15 row_newbcast:0 row_mask:0xf bank_mask:0xf
s_waitcnt vmcnt(4)
v_mfma_f32_16x16x32_bf16 v[40:43], v[48:51], v[140:143], v[40:43]
v_and_b32_dpp v48, v91, v12 row_newbcast:4 row_mask:0xf bank_mask:0xf
v_and_b32_dpp v49, v91, v13 row_newbcast:4 row_mask:0xf bank_mask:0xf
v_and_b32_dpp v50, v91, v14 row_newbcast:4 row_mask:0xf bank_mask:0xf
v_and_b32_dpp v51, v91, v15 row_newbcast:4 row_mask:0xf bank_mask:0xf
s_waitcnt vmcnt(3)
v_mfma_f32_16x16x32_bf16 v[40:43], v[44:47], v[144:147], v[40:43]
v_and_b32_dpp v44, v91, v12 row_newbcast:8 row_mask:0xf bank_mask:0xf
v_and_b32_dpp v45, v91, v13 row_newbcast:8 row_mask:0xf bank_mask:0xf
v_and_b32_dpp v46, v91, v14 row_newbcast:8 row_mask:0xf bank_mask:0xf
v_and_b32_dpp v47, v91, v15 row_newbcast:8 row_mask:0xf bank_mask:0xf
s_waitcnt vmcnt(2)
v_mfma_f32_16x16x32_bf16 v[40:43], v[48:51], v[148:151], v[40:43]
v_and_b32_dpp v48, v91, v12 row_newbcast:12 row_mask:0xf bank_mask:0xf
v_and_b32_dpp v49, v91, v13 row_newbcast:12 row_mask:0xf bank_mask:0xf
v_and_b32_dpp v50, v91, v14 row_newbcast:12 row_mask:0xf bank_mask:0xf
v_and_b32_dpp v51, v91, v15 row_newbcast:12 row_mask:0xf bank_mask:0xf
s_waitcnt vmcnt(1)
v_mfma_f32_16x16x32_bf16 v[40:43], v[44:47], v[152:155], v[40:43]
s_nop 1
s_waitcnt vmcnt(0)
v_mfma_f32_16x16x32_bf16 v[40:43], v[48:51], v[156:159], v[40:43]
L_wf:
s_waitcnt lgkmcnt(0)
v_cmp_ne_u32 vcc, s63, v5
s_cbranch_vccz L_wfd
s_sleep 1
ds_read_b64 v[4:5], v9 offset:576
s_sub_u32 s94, s94, 1
s_cbranch_scc0 L_wf
L_wfd:
s_mov_b32 exec_hi, 0
s_nop 3
v_mul_f32 v40, v40, v4
v_mul_f32 v41, v41, v4
v_mul_f32 v42, v42, v4
v_mul_f32 v43, v43, v4
ds_write_b128 v57, v[40:43] offset:6144
s_waitcnt lgkmcnt(0)
s_mov_b64 exec, -1
s_barrier
v_and_b32 v73, 31, v0
s_lshl_b32 s40, s28, 5
v_add_u32 v73, s40, v73
v_lshrrev_b32 v74, 5, v0
v_mul_u32_u24 v68, 2304, v73
v_lshl_add_u32 v68, v74, 4, v68
s_min_u32 s41, s2, 71
s_lshl_b32 s40, s41, 5
v_add_u32 v68, s40, v68
s_lshl_b32 s40, s41, 4
v_lshl_add_u32 v69, v0, 1, s40
v_lshlrev_b32 v70, 2, v0
s_lshl_b32 s40, s28, 5
v_lshl_add_u32 v71, v74, 4, s40
s_mov_b32 s36, s4
s_mov_b32 s37, s5
s_mov_b32 s38, 1152
s_mov_b32 s39, 0x20000
s_mov_b32 s84, s22
s_mov_b32 s85, s23
s_mov_b32 s86, 1152
s_mov_b32 s87, 0x20000
buffer_load_ushort v72, v69, s[36:39], 0 offen
s_mov_b32 s98, -1
s_mov_b32 s99, -1
s_branch L_final
.section .rodata,"a"
.p2align 6
.amdhsa_kernel parallel_sum__mha_block_cached__glu_gated_bilinear__decode_kernel
  .amdhsa_next_free_vgpr 256
  .amdhsa_next_free_sgpr 100
  .amdhsa_accum_offset 256
  .amdhsa_group_segment_fixed_size 0
  .amdhsa_kernarg_size 96
  .amdhsa_user_sgpr_count 2
  .amdhsa_user_sgpr_kernarg_segment_ptr 1
  .amdhsa_system_sgpr_workgroup_id_x 1
.end_amdhsa_kernel
```
